```python
import torch

def _softmax(x, axis=-1):
    return torch.softmax(x, dim=axis)
def _gelu(x):
    return torch.nn.functional.gelu(x, approximate="tanh")
def _silu(x):
    return torch.nn.functional.silu(x)
def _sigmoid(x):
    return torch.sigmoid(x)
def _layernorm(x, axis=-1, eps=1e-5):
    m = x.mean(dim=axis, keepdim=True)
    v = x.var(dim=axis, keepdim=True, unbiased=False)
    return (x - m) / torch.sqrt(v + eps)
def _scatter_add(tgt, idx, src, axis=0):
    return tgt.clone().index_add_(axis, idx, src)
def _segment_sum(src, seg, n):
    out = torch.zeros((n,) + src.shape[1:], dtype=src.dtype)
    return out.index_add_(0, seg, src)
def _pad(x, pw):
    flat = tuple(v for pair in reversed(pw) for v in pair)
    return torch.nn.functional.pad(x, flat)

kernel_name = 'sequential_preLN__mha_block_cached__mixer_channel_mlp__decode'

def setup_inputs():

    _w = (lambda a: (lambda t: t.to(torch.bfloat16) if t.is_floating_point() else t)(torch.as_tensor(a)))
    def _A_setup():
        B, Sq, D = 2, 1, 512
        H, Sk, Dh = 32, 8192, 128
        return {
            "x": _w((lambda *s: torch.randn(*s, dtype=torch.bfloat16) * 0.05)(B, Sq, D)),
            "k_cache": _w((lambda *s: torch.randn(*s, dtype=torch.bfloat16) * 3.2)(B, H, Sk, Dh)),
            "v_cache": _w((lambda *s: torch.randn(*s, dtype=torch.bfloat16) * 0.4)(B, H, Sk, Dh)),
            "wq": _w((lambda *s: torch.randn(*s, dtype=torch.bfloat16) * 3.2)(D, H * Dh) * (D ** -0.5)),
            "wo": _w((lambda *s: torch.randn(*s, dtype=torch.bfloat16) * 0.4)(H * Dh, D) * ((H * Dh) ** -0.5)),
        }
    _A_in = _A_setup()

    def _B_setup():
        B, S, D, F = 2, 1, 512, 1792
        return {
            "x": _w((lambda *s: torch.randn(*s, dtype=torch.bfloat16) * 0.05)(B, S, D)),
            "w1": _w((lambda *s: torch.randn(*s, dtype=torch.bfloat16) * 3.2)(D, F) * (D ** -0.5)),
            "b1": _w((lambda *s: torch.randn(*s, dtype=torch.bfloat16) * 3.2)(F)),
            "w2": _w((lambda *s: torch.randn(*s, dtype=torch.bfloat16) * 0.8)(F, D) * (F ** -0.5)),
            "b2": _w((lambda *s: torch.randn(*s, dtype=torch.bfloat16) * 1.6)(D)),
        }
    _B_in = _B_setup()

    return {
        "A_x": _A_in["x"],
        "A_k_cache": _A_in["k_cache"],
        "A_v_cache": _A_in["v_cache"],
        "A_wq": _A_in["wq"],
        "A_wo": _A_in["wo"],
        "B_x": _B_in["x"],
        "B_w1": _B_in["w1"],
        "B_b1": _B_in["b1"],
        "B_w2": _B_in["w2"],
        "B_b2": _B_in["b2"],
    }

def reference(A_x, A_k_cache, A_v_cache, A_wq, A_wo, B_x, B_w1, B_b1, B_w2, B_b2):
    def _A_ref(x, k_cache, v_cache, wq, wo):
        B, Sq, D = x.shape
        H, Dh = 32, 128
        q = (lambda x, *d: x.permute(*d))((x @ wq).reshape(B, Sq, H, Dh), 0, 2, 1, 3)
        scores = torch.einsum("bhqd,bhkd->bhqk", q, k_cache) * (Dh ** -0.5)
        p = _softmax(scores, axis=-1)
        o = torch.einsum("bhqk,bhkd->bhqd", p, v_cache)
        return (lambda x, *d: x.permute(*d))(o, 0, 2, 1, 3).reshape(B, Sq, H * Dh) @ wo

    def _B_ref(x, w1, b1, w2, b2):
        y = _layernorm(x, axis=-1)
        h = _gelu(torch.einsum("bsd,df->bsf", y, w1) + b1)
        return torch.einsum("bsf,fd->bsd", h, w2) + b2

    x = A_x
    h = x + _A_ref(_layernorm(x, axis=-1), A_k_cache, A_v_cache, A_wq, A_wo)
    h2 = h + _B_ref(_layernorm(h, axis=-1), B_w1, B_b1, B_w2, B_b2)
    return h2
```

```asm
; @launch grid=(256,1,1) block=(256,1,1) lds=16384
.amdgcn_target "amdgcn-amd-amdhsa--gfx950"
.text
.globl sequential_preLN__mha_block_cached__mixer_channel_mlp__decode_kernel
.p2align 8
.type sequential_preLN__mha_block_cached__mixer_channel_mlp__decode_kernel,@function
sequential_preLN__mha_block_cached__mixer_channel_mlp__decode_kernel:
  s_cmp_ge_u32 s2, 256
  s_cbranch_scc1 L_end
  s_load_dwordx16 s[4:19], s[0:1], 0
  s_load_dwordx8 s[20:27], s[0:1], 64
  s_load_dwordx2 s[28:29], s[0:1], 96
  v_and_b32 v1, 63, v0
  v_lshrrev_b32 v124, 6, v0
  v_and_b32 v2, 15, v0
  v_readfirstlane_b32 s3, v124
  v_lshrrev_b32 v3, 4, v1
  s_and_b32 s82, s2, 31
  s_lshr_b32 s83, s2, 5
  s_and_b32 s83, s83, 1
  s_lshr_b32 s84, s2, 6
  s_and_b32 s85, s2, 63
  s_lshl_b32 s81, s3, 12
  v_lshrrev_b32 v124, 1, v2
  v_lshlrev_b32 v124, 8, v124
  v_and_b32 v125, 1, v2
  v_lshl_add_u32 v124, v125, 6, v124
  v_lshl_add_u32 v124, v3, 4, v124
  v_add_u32 v4, s81, v124
  v_lshlrev_b32 v124, 9, v3
  v_lshl_add_u32 v124, v2, 4, v124
  v_add_u32 v5, s81, v124
  s_lshl_b32 s81, s3, 20
  v_lshlrev_b32 v124, 18, v3
  v_lshl_add_u32 v124, v2, 4, v124
  v_add_u32 v6, s81, v124
  s_lshr_b32 s99, s2, 5
  s_lshl_b32 s81, s3, 17
  v_lshlrev_b32 v124, 15, v3
  v_lshl_add_u32 v124, v2, 4, v124
  v_add_u32 v6, s81, v124
  s_mul_i32 s81, s82, 17408
  s_add_u32 s81, s81, 1310720
  v_mov_b32 v148, s81
  s_lshl_b32 s88, s99, 11
  s_add_u32 s88, s88, s81
  s_add_u32 s88, s88, 1024
  s_lshl_b32 s98, s3, 9
  s_add_u32 s88, s88, s98
  v_lshlrev_b32 v124, 4, v1
  v_add_u32 v125, s88, v124
  v_mov_b32 v127, 2146435072
  v_cmp_gt_u32 vcc, 32, v1
  s_nop 1
  v_cndmask_b32 v149, v127, v125, vcc
  s_lshl_b32 s88, s3, 12
  s_add_u32 s88, s88, s81
  s_lshl_b32 s98, s83, 10
  s_add_u32 s88, s88, s98
  s_add_u32 s88, s88, 1024
  v_add_u32 v150, s88, v124
  s_mov_b32 s98, 0
  s_lshl_b32 s81, s83, 10
  v_lshlrev_b32 v126, 4, v1
  v_add_u32 v126, s81, v126
  v_lshrrev_b32 v126, 5, v1
  v_lshlrev_b32 v126, 10, v126
  v_and_b32 v127, 31, v1
  v_lshl_add_u32 v126, v127, 5, v126
  s_lshl_b32 s81, s83, 5
  s_lshl_b32 s88, s3, 3
  s_add_u32 s81, s81, s88
  s_lshl_b32 s81, s81, 13
  s_lshl_b32 s88, s82, 2
  s_add_u32 s88, s88, s84
  s_lshl_b32 s88, s88, 6
  s_add_u32 s81, s81, s88
  s_add_u32 s81, s81, 65536
  v_lshlrev_b32 v124, 1, v3
  v_lshrrev_b32 v125, 2, v2
  v_add_u32 v124, v124, v125
  v_lshlrev_b32 v124, 13, v124
  v_and_b32 v125, 3, v2
  v_lshl_add_u32 v124, v125, 4, v124
  v_add_u32 v124, s81, v124
  v_mov_b32 v125, 2146435072
  v_cmp_gt_u32 vcc, 8, v2
  s_nop 1
  v_cndmask_b32 v8, v125, v124, vcc
  v_lshrrev_b32 v124, 2, v2
  v_lshlrev_b32 v124, 1, v124
  v_lshrrev_b32 v125, 1, v3
  v_add_u32 v124, v124, v125
  v_lshlrev_b32 v124, 13, v124
  v_and_b32 v125, 3, v2
  v_lshl_add_u32 v124, v125, 4, v124
  v_and_b32 v125, 1, v3
  v_lshl_add_u32 v124, v125, 3, v124
  v_add_u32 v8, s81, v124
  v_mov_b32 v243, 2146435072
  s_lshl_b32 s88, s3, 9
  v_lshrrev_b32 v124, 3, v2
  v_lshlrev_b32 v124, 8, v124
  v_lshl_add_u32 v124, v3, 6, v124
  v_and_b32 v125, 7, v2
  v_lshl_add_u32 v124, v125, 3, v124
  v_add_u32 v244, s88, v124
  v_lshrrev_b32 v124, 2, v2
  v_lshlrev_b32 v124, 9, v124
  v_and_b32 v125, 1, v2
  v_lshl_add_u32 v124, v125, 8, v124
  v_lshl_add_u32 v245, v3, 4, v124
  s_lshl_b32 s81, s85, 7
  s_lshl_b32 s88, s84, 2
  s_add_u32 s88, s88, s3
  s_lshl_b32 s88, s88, 3
  s_add_u32 s88, s88, s81
  v_mov_b32 v124, s88
  v_mov_b32 v125, 2146435072
  v_cmp_eq_u32 vcc, 0, v1
  s_nop 1
  v_cndmask_b32 v9, v125, v124, vcc
  v_lshlrev_b32 v124, 3, v2
  v_add_u32 v10, s81, v124
  s_mov_b32 s86, 0
  s_and_b32 s81, s2, 7
  s_mul_i32 s81, s81, 14
  s_lshr_b32 s88, s2, 3
  s_add_u32 s89, s81, s88
  s_cmp_lt_u32 s2, 112
  s_cselect_b32 s86, 1, 0
  s_sub_u32 s81, s2, 128
  s_cmp_lt_u32 s81, 64
  s_cselect_b32 s86, 2, s86
  s_cselect_b32 s89, s81, s89
  v_mov_b32 v11, 2146435072
  v_mov_b32 v232, 2146435072
  v_mov_b32 v233, 2146435072
  v_mov_b32 v234, 2146435072
  v_mov_b32 v235, 2146435072
  v_mov_b32 v218, 2146435072
  v_mov_b32 v239, 2146435072
  v_mov_b32 v240, 2146435072
  v_mov_b32 v241, 2146435072
  s_cmp_eq_u32 s86, 1
  s_cbranch_scc0 L_r1
  v_lshrrev_b32 v124, 3, v2
  v_lshlrev_b32 v124, 5, v124
  v_lshl_add_u32 v124, v3, 1, v124
  v_bfe_u32 v125, v2, 2, 1
  v_add_u32 v124, v124, v125
  s_lshl_b32 s81, s3, 3
  v_add_u32 v124, s81, v124
  v_mul_u32_u24 v124, 7168, v124
  v_and_b32 v125, 3, v2
  v_lshl_add_u32 v124, v125, 4, v124
  s_lshl_b32 s81, s89, 6
  s_add_u32 s81, s81, 589824
  v_add_u32 v11, s81, v124
  v_lshrrev_b32 v124, 1, v3
  v_lshlrev_b32 v124, 2, v124
  v_and_b32 v125, 1, v3
  v_lshl_add_u32 v124, v125, 1, v124
  s_lshl_b32 s81, s3, 7
  v_add_u32 v124, s81, v124
  v_mul_u32_u24 v124, 3584, v124
  s_lshl_b32 s81, s89, 5
  v_lshl_add_u32 v124, v2, 1, v124
  v_add_u32 v232, s81, v124
  s_lshl_b32 s81, s89, 14
  s_lshl_b32 s88, s3, 8
  s_add_u32 s81, s81, s88
  v_lshlrev_b32 v124, 12, v3
  v_lshl_add_u32 v124, v2, 4, v124
  v_add_u32 v233, s81, v124
  s_lshl_b32 s81, s89, 5
  v_and_b32 v124, 3, v2
  v_lshl_add_u32 v124, v3, 2, v124
  v_lshlrev_b32 v124, 1, v124
  v_add_u32 v234, s81, v124
  v_lshrrev_b32 v124, 5, v1
  v_lshlrev_b32 v124, 11, v124
  v_and_b32 v125, 31, v1
  v_lshl_add_u32 v124, v125, 4, v124
  v_add_u32 v235, 8192, v124
  s_and_b32 s81, s2, 3
  s_lshl_b32 s81, s81, 12
  v_add_u32 v235, s81, v235
  s_branch L_r2
L_r1:
  s_cmp_eq_u32 s86, 2
  s_cbranch_scc0 L_r2
  s_cmp_eq_u32 s3, 0
  s_cbranch_scc0 L_r2
  s_lshl_b32 s81, s89, 6
  s_add_u32 s81, s81, 8192
  v_and_b32 v124, 3, v2
  v_lshlrev_b32 v124, 2, v124
  v_lshl_add_u32 v124, v3, 4, v124
  v_lshrrev_b32 v125, 2, v2
  v_lshl_add_u32 v124, v125, 12, v124
  v_add_u32 v11, s81, v124
  s_and_b32 s81, s89, 31
  s_lshr_b32 s88, s81, 1
  s_lshl_b32 s88, s88, 5
  s_and_b32 s81, s81, 1
  s_lshl_b32 s81, s81, 2
  s_add_u32 s81, s81, s88
  v_and_b32 v124, 3, v2
  v_lshl_add_u32 v124, v124, 3, v3
  v_add_u32 v124, s81, v124
  s_lshr_b32 s88, s89, 5
  s_lshl_b32 s88, s88, 10
  v_lshlrev_b32 v124, 1, v124
  v_add_u32 v243, s88, v124
  v_and_b32 v124, 3, v2
  v_lshl_add_u32 v124, v3, 3, v124
  v_add_u32 v124, s81, v124
  v_lshlrev_b32 v240, 1, v124
  s_lshr_b32 s81, s89, 5
  s_lshl_b32 s81, s81, 10
  v_add_u32 v239, s81, v240
  v_mov_b32 v125, 2146435072
  v_cmp_gt_u32 vcc, 4, v2
  s_nop 1
  v_cndmask_b32 v218, v125, v239, vcc
  s_lshl_b32 s81, s89, 13
  s_add_u32 s81, s81, 65536
  v_lshlrev_b32 v124, 4, v1
  v_add_u32 v235, s81, v124
  s_mul_i32 s81, s89, 7168
  s_add_u32 s81, s81, 589824
  v_add_u32 v241, s81, v124
L_r2:
  v_mov_b32 v220, -1
  v_mov_b32 v221, -1
  v_mov_b32 v222, -1
  v_mov_b32 v223, -1
  s_waitcnt lgkmcnt(0)
  s_lshl_b32 s81, s85, 21
  s_lshl_b32 s88, s84, 19
  s_add_u32 s81, s81, s88
  s_mov_b32 s56, s4
  s_and_b32 s57, s5, 0xffff
  s_mov_b32 s58, 2048
  s_mov_b32 s59, 0x20000
  buffer_load_dwordx4 v[192:195], v126, s[56:59], 0 offen
  buffer_load_dwordx4 v[196:199], v126, s[56:59], 0 offen offset:16
  s_lshl_b32 s88, s82, 8
  s_add_u32 s40, s10, s88
  s_addc_u32 s41, s11, 0
  s_and_b32 s41, s41, 0xffff
  s_mov_b32 s42, 0
  s_mov_b32 s43, 0x20000
  s_sub_u32 s42, 4194304, s88
  s_lshl_b32 s88, s99, 19
  buffer_load_dwordx4 a[128:131], v6, s[40:43], s88 offen
  s_add_u32 s88, s88, 8192
  buffer_load_dwordx4 a[132:135], v6, s[40:43], s88 offen
  s_add_u32 s88, s88, 8192
  buffer_load_dwordx4 a[136:139], v6, s[40:43], s88 offen
  s_add_u32 s88, s88, 8192
  buffer_load_dwordx4 a[140:143], v6, s[40:43], s88 offen
  s_mov_b32 s48, s28
  s_and_b32 s49, s29, 0xffff
  s_mov_b32 s50, 1867776
  s_mov_b32 s51, 0x20000
  buffer_load_dwordx2 v[146:147], v148, s[48:51], 0 offen sc1
  s_add_u32 s32, s6, s81
  s_addc_u32 s33, s7, 0
  s_and_b32 s33, s33, 0xffff
  s_mov_b32 s34, 524288
  s_mov_b32 s35, 0x20000
  s_mov_b32 s80, 0
  buffer_load_dwordx4 a[0:3], v4, s[32:35], s80 offen offset:0 nt
  buffer_load_dwordx4 a[4:7], v4, s[32:35], s80 offen offset:2048 nt
  buffer_load_dwordx4 a[8:11], v4, s[32:35], s80 offen offset:128 nt
  buffer_load_dwordx4 a[12:15], v4, s[32:35], s80 offen offset:2176 nt
  s_mov_b32 s80, 16384
  buffer_load_dwordx4 a[16:19], v4, s[32:35], s80 offen offset:0 nt
  s_add_u32 s36, s8, s81
  s_addc_u32 s37, s9, 0
  s_and_b32 s37, s37, 0xffff
  s_mov_b32 s38, 524288
  s_mov_b32 s39, 0x20000
  s_lshl_b32 s81, s82, 8
  buffer_store_dwordx2 v[220:221], v8, s[48:51], 0 offen sc1
  buffer_store_dwordx2 v[220:221], v9, s[48:51], 0 offen sc1
  s_cmp_eq_u32 s86, 1
  s_cbranch_scc0 L_i1
  buffer_store_dwordx4 v[220:223], v11, s[48:51], 0 offen sc1
L_i1:
  s_cmp_eq_u32 s86, 2
  s_cbranch_scc0 L_i2
  buffer_store_dword v220, v11, s[48:51], 0 offen sc1
L_i2:
  s_lshl_b32 s81, s82, 17
  s_add_u32 s44, s12, s81
  s_addc_u32 s45, s13, 0
  s_and_b32 s45, s45, 0xffff
  s_mov_b32 s46, 131072
  s_mov_b32 s47, 0x20000
  s_mov_b32 s52, s26
  s_and_b32 s53, s27, 0xffff
  s_mov_b32 s54, 256
  s_mov_b32 s55, 0x20000
  s_mov_b32 s60, s16
  s_and_b32 s61, s17, 0xffff
  s_mov_b32 s62, 1835008
  s_mov_b32 s63, 0x20000
  s_mov_b32 s64, s20
  s_and_b32 s65, s21, 0xffff
  s_mov_b32 s66, 1835008
  s_mov_b32 s67, 0x20000
  s_mov_b32 s68, s18
  s_and_b32 s69, s19, 0xffff
  s_mov_b32 s70, 3584
  s_mov_b32 s71, 0x20000
  s_mov_b32 s72, s22
  s_and_b32 s73, s23, 0xffff
  s_mov_b32 s74, 1024
  s_mov_b32 s75, 0x20000
  s_mov_b32 s76, s24
  s_and_b32 s77, s25, 0xffff
  s_mov_b32 s78, 2048
  s_mov_b32 s79, 0x20000
  s_mov_b32 s92, 0x05040100
  s_lshl_b32 s81, s3, 8
  v_lshlrev_b32 v124, 11, v3
  v_lshl_add_u32 v124, v2, 4, v124
  v_add_u32 v7, s81, v124
  s_mov_b32 s100, 0x07060302
  s_lshr_b32 s93, s2, 4
  s_and_b32 s93, s93, 15
  s_cmp_eq_u32 s3, 0
  s_cselect_b32 s93, s93, 99
  v_mov_b32 v237, 1
  s_lshr_b32 s81, s2, 3
  s_and_b32 s81, s81, 3
  s_lshl_b32 s81, s81, 5
  s_mov_b32 s95, s81
  s_cmp_eq_u32 s3, 0
  s_cselect_b32 s81, s81, 2146435072
  v_mov_b32 v238, 2146435072
  v_mov_b32 v124, s81
  v_cmp_eq_u32 vcc, 0, v1
  s_nop 1
  v_cndmask_b32 v238, v238, v124, vcc
  s_add_u32 s94, s95, 128
  s_mov_b32 s95, 2146435072
  s_cmp_eq_u32 s3, 0
  s_cselect_b32 s94, s94, s95
  v_mov_b32 v246, 2146435072
  v_mov_b32 v247, s94
  v_cmp_eq_u32 vcc, 0, v1
  s_nop 1
  v_cndmask_b32 v246, v246, v247, vcc
  s_mov_b32 s95, 15616
  s_cmp_eq_u32 s3, 0
  s_cselect_b32 s94, 15360, s95
  v_mov_b32 v248, s94
  v_mov_b32 v249, 15360
  v_mov_b32 v247, 0
  ds_write_b32 v249, v247
  s_mov_b32 s94, 0
  s_waitcnt lgkmcnt(0)
  v_mov_b32 v247, 1
  v_and_b32 v124, 1, v2
  v_cmp_eq_u32 vcc, 1, v124
  v_mov_b32 v125, 0x0c0c0100
  v_mov_b32 v126, 0x01000c0c
  v_cndmask_b32 v127, v125, v126, vcc
  v_mov_b32 v125, 0x0c0c0302
  v_mov_b32 v126, 0x03020c0c
  v_cndmask_b32 v128, v125, v126, vcc
  v_mov_b32 v125, 0x0000ffff
  v_mov_b32 v126, 0xffff0000
  v_cndmask_b32 v129, v125, v126, vcc
  v_bfe_u32 v124, v2, 1, 2
  v_mov_b32 v130, 0x0c0c0c0c
  v_cmp_eq_u32 vcc, 0, v124
  s_nop 1
  v_cndmask_b32 v12, v130, v127, vcc
  v_cndmask_b32 v16, v130, v128, vcc
  v_cndmask_b32 v20, 0, v129, vcc
  v_cmp_eq_u32 vcc, 1, v124
  s_nop 1
  v_cndmask_b32 v13, v130, v127, vcc
  v_cndmask_b32 v17, v130, v128, vcc
  v_cndmask_b32 v21, 0, v129, vcc
  v_cmp_eq_u32 vcc, 2, v124
  s_nop 1
  v_cndmask_b32 v14, v130, v127, vcc
  v_cndmask_b32 v18, v130, v128, vcc
  v_cndmask_b32 v22, 0, v129, vcc
  v_cmp_eq_u32 vcc, 3, v124
  s_nop 1
  v_cndmask_b32 v15, v130, v127, vcc
  v_cndmask_b32 v19, v130, v128, vcc
  v_cndmask_b32 v23, 0, v129, vcc
  s_lshl_b32 s81, s3, 11
  v_lshlrev_b32 v124, 5, v1
  v_add_u32 v224, s81, v124
  s_lshl_b32 s88, s99, 2
  s_add_u32 s88, s88, s3
  s_lshl_b32 s88, s88, 5
  s_add_u32 s81, s81, s88
  v_lshrrev_b32 v124, 3, v2
  v_lshlrev_b32 v124, 10, v124
  v_lshl_add_u32 v124, v3, 3, v124
  v_add_u32 v225, s81, v124
  s_waitcnt vmcnt(12)
  buffer_load_dwordx4 a[20:23], v4, s[32:35], s80 offen offset:2048 nt
  buffer_load_dwordx4 a[24:27], v4, s[32:35], s80 offen offset:128 nt
  buffer_load_dwordx4 a[28:31], v4, s[32:35], s80 offen offset:2176 nt
  v_lshlrev_b32 v176, 16, v192
  v_and_b32 v177, 0xffff0000, v192
  v_lshlrev_b32 v178, 16, v193
  v_and_b32 v179, 0xffff0000, v193
  v_lshlrev_b32 v180, 16, v194
  v_and_b32 v181, 0xffff0000, v194
  v_lshlrev_b32 v182, 16, v195
  v_and_b32 v183, 0xffff0000, v195
  v_lshlrev_b32 v184, 16, v196
  v_and_b32 v185, 0xffff0000, v196
  v_lshlrev_b32 v186, 16, v197
  v_and_b32 v187, 0xffff0000, v197
  v_lshlrev_b32 v188, 16, v198
  v_and_b32 v189, 0xffff0000, v198
  v_lshlrev_b32 v190, 16, v199
  v_and_b32 v191, 0xffff0000, v199
  v_add_f32 v134, v176, v177
  v_add_f32 v134, v134, v178
  v_add_f32 v134, v134, v179
  v_add_f32 v134, v134, v180
  v_add_f32 v134, v134, v181
  v_add_f32 v134, v134, v182
  v_add_f32 v134, v134, v183
  v_add_f32 v134, v134, v184
  v_add_f32 v134, v134, v185
  v_add_f32 v134, v134, v186
  v_add_f32 v134, v134, v187
  v_add_f32 v134, v134, v188
  v_add_f32 v134, v134, v189
  v_add_f32 v134, v134, v190
  v_add_f32 v134, v134, v191
  s_nop 1
  v_add_f32_dpp v134, v134, v134 row_ror:1 row_mask:0xf bank_mask:0xf
  s_nop 1
  v_add_f32_dpp v134, v134, v134 row_ror:2 row_mask:0xf bank_mask:0xf
  s_nop 1
  v_add_f32_dpp v134, v134, v134 row_ror:4 row_mask:0xf bank_mask:0xf
  s_nop 1
  v_add_f32_dpp v134, v134, v134 row_ror:8 row_mask:0xf bank_mask:0xf
  v_mov_b32 v135, v134
  s_nop 1
  v_permlane16_swap_b32 v134, v135
  v_add_f32 v134, v134, v135
  v_mul_f32 v134, 0x3b000000, v134
  v_sub_f32 v135, v176, v134
  v_mul_f32 v133, v135, v135
  v_sub_f32 v135, v177, v134
  v_fmac_f32 v133, v135, v135
  v_sub_f32 v135, v178, v134
  v_fmac_f32 v133, v135, v135
  v_sub_f32 v135, v179, v134
  v_fmac_f32 v133, v135, v135
  v_sub_f32 v135, v180, v134
  v_fmac_f32 v133, v135, v135
  v_sub_f32 v135, v181, v134
  v_fmac_f32 v133, v135, v135
  v_sub_f32 v135, v182, v134
  v_fmac_f32 v133, v135, v135
  v_sub_f32 v135, v183, v134
  v_fmac_f32 v133, v135, v135
  v_sub_f32 v135, v184, v134
  v_fmac_f32 v133, v135, v135
  v_sub_f32 v135, v185, v134
  v_fmac_f32 v133, v135, v135
  v_sub_f32 v135, v186, v134
  v_fmac_f32 v133, v135, v135
  v_sub_f32 v135, v187, v134
  v_fmac_f32 v133, v135, v135
  v_sub_f32 v135, v188, v134
  v_fmac_f32 v133, v135, v135
  v_sub_f32 v135, v189, v134
  v_fmac_f32 v133, v135, v135
  v_sub_f32 v135, v190, v134
  v_fmac_f32 v133, v135, v135
  v_sub_f32 v135, v191, v134
  v_fmac_f32 v133, v135, v135
  s_nop 1
  v_add_f32_dpp v133, v133, v133 row_ror:1 row_mask:0xf bank_mask:0xf
  s_nop 1
  v_add_f32_dpp v133, v133, v133 row_ror:2 row_mask:0xf bank_mask:0xf
  s_nop 1
  v_add_f32_dpp v133, v133, v133 row_ror:4 row_mask:0xf bank_mask:0xf
  s_nop 1
  v_add_f32_dpp v133, v133, v133 row_ror:8 row_mask:0xf bank_mask:0xf
  v_mov_b32 v135, v133
  s_nop 1
  v_permlane16_swap_b32 v133, v135
  v_add_f32 v133, v133, v135
  v_mov_b32 v135, v133
  v_mul_f32 v135, 0x3b000000, v135
  v_cvt_pk_bf16_f32 v135, 0, v135
  v_add_f32 v135, 0x3727c5ac, v135
  v_cvt_pk_bf16_f32 v135, 0, v135
  v_sqrt_f32 v135, v135
  s_nop 0
  v_cvt_pk_bf16_f32 v135, 0, v135
  v_rcp_f32 v133, v135
  v_cvt_pk_bf16_f32 v132, 0, v134
  v_sub_f32 v176, v176, v132
  v_sub_f32 v177, v177, v132
  v_cvt_pk_bf16_f32 v177, v176, v177
  v_lshlrev_b32 v176, 16, v177
  v_and_b32 v177, 0xffff0000, v177
  v_mul_f32 v176, v176, v133
  v_mul_f32 v177, v177, v133
  v_sub_f32 v178, v178, v132
  v_sub_f32 v179, v179, v132
  v_cvt_pk_bf16_f32 v179, v178, v179
  v_lshlrev_b32 v178, 16, v179
  v_and_b32 v179, 0xffff0000, v179
  v_mul_f32 v178, v178, v133
  v_mul_f32 v179, v179, v133
  v_sub_f32 v180, v180, v132
  v_sub_f32 v181, v181, v132
  v_cvt_pk_bf16_f32 v181, v180, v181
  v_lshlrev_b32 v180, 16, v181
  v_and_b32 v181, 0xffff0000, v181
  v_mul_f32 v180, v180, v133
  v_mul_f32 v181, v181, v133
  v_sub_f32 v182, v182, v132
  v_sub_f32 v183, v183, v132
  v_cvt_pk_bf16_f32 v183, v182, v183
  v_lshlrev_b32 v182, 16, v183
  v_and_b32 v183, 0xffff0000, v183
  v_mul_f32 v182, v182, v133
  v_mul_f32 v183, v183, v133
  v_sub_f32 v184, v184, v132
  v_sub_f32 v185, v185, v132
  v_cvt_pk_bf16_f32 v185, v184, v185
  v_lshlrev_b32 v184, 16, v185
  v_and_b32 v185, 0xffff0000, v185
  v_mul_f32 v184, v184, v133
  v_mul_f32 v185, v185, v133
  v_sub_f32 v186, v186, v132
  v_sub_f32 v187, v187, v132
  v_cvt_pk_bf16_f32 v187, v186, v187
  v_lshlrev_b32 v186, 16, v187
  v_and_b32 v187, 0xffff0000, v187
  v_mul_f32 v186, v186, v133
  v_mul_f32 v187, v187, v133
  v_sub_f32 v188, v188, v132
  v_sub_f32 v189, v189, v132
  v_cvt_pk_bf16_f32 v189, v188, v189
  v_lshlrev_b32 v188, 16, v189
  v_and_b32 v189, 0xffff0000, v189
  v_mul_f32 v188, v188, v133
  v_mul_f32 v189, v189, v133
  v_sub_f32 v190, v190, v132
  v_sub_f32 v191, v191, v132
  v_cvt_pk_bf16_f32 v191, v190, v191
  v_lshlrev_b32 v190, 16, v191
  v_and_b32 v191, 0xffff0000, v191
  v_mul_f32 v190, v190, v133
  v_mul_f32 v191, v191, v133
  v_cvt_pk_bf16_f32 v192, v176, v177
  v_cvt_pk_bf16_f32 v193, v178, v179
  v_cvt_pk_bf16_f32 v194, v180, v181
  v_cvt_pk_bf16_f32 v195, v182, v183
  v_cvt_pk_bf16_f32 v196, v184, v185
  v_cvt_pk_bf16_f32 v197, v186, v187
  v_cvt_pk_bf16_f32 v198, v188, v189
  v_cvt_pk_bf16_f32 v199, v190, v191
  ds_write_b128 v224, v[192:195] offset:7168
  ds_write_b128 v224, v[196:199] offset:7184
  s_mov_b32 s80, 32768
  buffer_load_dwordx4 a[32:35], v4, s[32:35], s80 offen offset:0 nt
  s_waitcnt lgkmcnt(0)
  ds_read_b64 v[104:105], v225 offset:7168
  s_lshl_b32 s81, s3, 9
  v_and_b32 v124, 7, v2
  v_lshl_add_u32 v124, v3, 5, v124
  v_lshlrev_b32 v124, 2, v124
  v_add_u32 v224, s81, v124
  v_mov_b32 v125, 6656
  v_cmp_gt_u32 vcc, 8, v2
  s_nop 1
  v_cndmask_b32 v217, v125, v224, vcc
  v_lshlrev_b32 v226, 3, v1
  s_waitcnt lgkmcnt(0)
  v_perm_b32 v88, v104, v104, v12
  v_perm_b32 v89, v104, v104, v13
  v_perm_b32 v90, v104, v104, v14
  v_perm_b32 v91, v104, v104, v15
  s_waitcnt vmcnt(15)
  s_nop 0
  v_mfma_f32_16x16x32_bf16 v[120:123], a[128:131], v[88:91], 0
  v_perm_b32 v92, v104, v104, v16
  v_perm_b32 v93, v104, v104, v17
  v_perm_b32 v94, v104, v104, v18
  v_perm_b32 v95, v104, v104, v19
  s_waitcnt vmcnt(14)
  s_nop 0
  v_mfma_f32_16x16x32_bf16 v[120:123], a[132:135], v[92:95], v[120:123]
  v_perm_b32 v88, v105, v105, v12
  v_perm_b32 v89, v105, v105, v13
  v_perm_b32 v90, v105, v105, v14
  v_perm_b32 v91, v105, v105, v15
  s_waitcnt vmcnt(13)
  s_nop 0
  v_mfma_f32_16x16x32_bf16 v[120:123], a[136:139], v[88:91], v[120:123]
  v_perm_b32 v92, v105, v105, v16
  v_perm_b32 v93, v105, v105, v17
  v_perm_b32 v94, v105, v105, v18
  v_perm_b32 v95, v105, v105, v19
  s_waitcnt vmcnt(12)
  s_nop 0
  v_mfma_f32_16x16x32_bf16 v[120:123], a[140:143], v[92:95], v[120:123]
  s_lshl_b32 s81, s3, 10
  v_and_b32 v124, 7, v2
  v_lshl_add_u32 v124, v3, 5, v124
  v_lshlrev_b32 v124, 2, v124
  v_lshrrev_b32 v125, 3, v2
  v_lshl_add_u32 v124, v125, 9, v124
  v_add_u32 v124, s81, v124
  s_lshl_b32 s81, s3, 8
  v_add_u32 v125, s81, v226
  ds_write_b32 v124, v120 offset:0
  ds_write_b32 v124, v121 offset:32
  ds_write_b32 v124, v122 offset:64
  ds_write_b32 v124, v123 offset:96
  buffer_load_dwordx4 a[36:39], v4, s[32:35], s80 offen offset:2048 nt
  s_waitcnt lgkmcnt(0)
  s_barrier
  ds_read_b64 v[126:127], v125 offset:0
  ds_read_b64 v[128:129], v125 offset:1024
  ds_read_b64 v[130:131], v125 offset:2048
  ds_read_b64 v[132:133], v125 offset:3072
  s_waitcnt vmcnt(12)
  v_add_u32 v144, 0x9e3779b9, v146
  v_add_u32 v145, 0x7f4a7c15, v147
  s_waitcnt lgkmcnt(0)
  v_pk_add_f32 v[126:127], v[126:127], v[128:129]
  v_pk_add_f32 v[130:131], v[130:131], v[132:133]
  v_pk_add_f32 v[126:127], v[126:127], v[130:131]
  v_mov_b32 v128, v144
  v_mov_b32 v129, v145
  buffer_store_dwordx4 v[126:129], v149, s[48:51], 0 offen sc1
  buffer_load_dwordx4 a[40:43], v4, s[32:35], s80 offen offset:128 nt
  buffer_load_dwordx4 a[44:47], v4, s[32:35], s80 offen offset:2176 nt
  s_waitcnt vmcnt(5)
  s_mov_b32 s80, 49152
  buffer_load_dwordx4 a[48:51], v4, s[32:35], s80 offen offset:0 nt
  s_waitcnt vmcnt(5)
  buffer_load_dwordx4 a[52:55], v4, s[32:35], s80 offen offset:2048 nt
  s_waitcnt vmcnt(5)
  buffer_load_dwordx4 a[56:59], v4, s[32:35], s80 offen offset:128 nt
  s_waitcnt vmcnt(4)
  buffer_load_dwordx4 a[60:63], v4, s[32:35], s80 offen offset:2176 nt
  s_waitcnt vmcnt(4)
  s_mov_b32 s80, 65536
  buffer_load_dwordx4 a[64:67], v4, s[32:35], s80 offen offset:0 nt
  buffer_load_dwordx4 v[200:203], v150, s[48:51], 0 offen sc1
  buffer_load_dwordx4 v[204:207], v150, s[48:51], 0 offen offset:2048 sc1
  s_waitcnt vmcnt(6)
  buffer_load_dwordx4 a[68:71], v4, s[32:35], s80 offen offset:2048 nt
  s_waitcnt vmcnt(6)
  buffer_load_dwordx4 a[72:75], v4, s[32:35], s80 offen offset:128 nt
  s_waitcnt vmcnt(6)
  buffer_load_dwordx4 a[76:79], v4, s[32:35], s80 offen offset:2176 nt
  s_waitcnt vmcnt(6)
  s_mov_b32 s80, 81920
  buffer_load_dwordx4 a[80:83], v4, s[32:35], s80 offen offset:0 nt
  s_waitcnt vmcnt(6)
  buffer_load_dwordx4 a[84:87], v4, s[32:35], s80 offen offset:2048 nt
  s_cmp_eq_u32 s98, 1
  s_cbranch_scc1 L_qc1
  s_waitcnt vmcnt(5)
  v_cmp_ne_u32 vcc, v144, v202
  v_cmp_ne_u32 s[90:91], v145, v203
  s_or_b64 vcc, vcc, s[90:91]
  v_cmp_ne_u32 s[90:91], v144, v206
  s_or_b64 vcc, vcc, s[90:91]
  v_cmp_ne_u32 s[90:91], v145, v207
  s_or_b64 vcc, vcc, s[90:91]
  s_cbranch_vccnz L_qc1
  s_mov_b32 s98, 1
L_qc1:
  s_cmp_eq_u32 s98, 1
  s_cbranch_scc1 L_qok
  s_mov_b32 s87, 32768
L_qspin:
  buffer_load_dwordx4 v[200:203], v150, s[48:51], 0 offen sc1
  buffer_load_dwordx4 v[204:207], v150, s[48:51], 0 offen offset:2048 sc1
  s_waitcnt vmcnt(0)
  v_cmp_ne_u32 vcc, v144, v202
  v_cmp_ne_u32 s[90:91], v145, v203
  s_or_b64 vcc, vcc, s[90:91]
  v_cmp_ne_u32 s[90:91], v144, v206
  s_or_b64 vcc, vcc, s[90:91]
  v_cmp_ne_u32 s[90:91], v145, v207
  s_or_b64 vcc, vcc, s[90:91]
  s_cbranch_vccz L_qok
  s_sub_u32 s87, s87, 1
  s_cbranch_scc0 L_qspin
L_qok:
  v_pk_add_f32 v[200:201], v[200:201], v[204:205]
  s_lshl_b32 s81, s3, 9
  v_add_u32 v124, s81, v226
  ds_write_b64 v124, v[200:201] offset:4096
  buffer_load_dwordx4 a[88:91], v4, s[32:35], s80 offen offset:128 nt
  buffer_load_dwordx4 a[92:95], v4, s[32:35], s80 offen offset:2176 nt
  s_waitcnt lgkmcnt(0)
  s_barrier
  s_cmp_eq_u32 s3, 0
  s_cbranch_scc0 L_c1
  v_mov_b32 v124, 1
  v_mov_b32 v125, 2146435072
  v_cmp_eq_u32 vcc, 0, v1
  s_nop 1
  v_cndmask_b32 v125, v125, 0, vcc
L_c1:
  ds_read_b64 v[126:127], v226 offset:4096
  ds_read_b64 v[128:129], v226 offset:4608
  ds_read_b64 v[130:131], v226 offset:5120
  ds_read_b64 v[132:133], v226 offset:5632
  s_lshl_b32 s81, s3, 8
  v_lshlrev_b32 v124, 2, v1
  v_add_u32 v124, s81, v124
  v_lshrrev_b32 v125, 3, v2
  v_lshlrev_b32 v125, 6, v125
  v_lshl_add_u32 v125, v3, 4, v125
  v_add_u32 v125, s81, v125
  s_waitcnt lgkmcnt(0)
  v_pk_add_f32 v[126:127], v[126:127], v[128:129]
  v_pk_add_f32 v[130:131], v[130:131], v[132:133]
  v_pk_add_f32 v[126:127], v[126:127], v[130:131]
  v_cvt_pk_bf16_f32 v126, v126, v127
  ds_write_b32 v124, v126 offset:6144
  s_waitcnt lgkmcnt(0)
  ds_read_b128 v[24:27], v125 offset:6144
  ds_read_b128 v[28:31], v125 offset:6272
  v_mov_b32 v140, 0xff800000
  v_mov_b32 v80, 0
  v_mov_b32 v81, 0
  v_mov_b32 v82, 0
  v_mov_b32 v83, 0
  v_mov_b32 v84, 0
  v_mov_b32 v85, 0
  v_mov_b32 v86, 0
  v_mov_b32 v87, 0
  s_waitcnt lgkmcnt(0)
  s_waitcnt vmcnt(5)
  s_mov_b32 s80, 98304
  buffer_load_dwordx4 a[96:99], v4, s[32:35], s80 offen offset:0 nt
  v_mfma_f32_16x16x32_bf16 v[64:67], a[0:3], v[24:27], 0
  v_mfma_f32_16x16x32_bf16 v[68:71], a[4:7], v[24:27], 0
  s_waitcnt vmcnt(5)
  buffer_load_dwordx4 a[100:103], v4, s[32:35], s80 offen offset:2048 nt
  v_mfma_f32_16x16x32_bf16 v[64:67], a[8:11], v[28:31], v[64:67]
  s_waitcnt vmcnt(5)
  buffer_load_dwordx4 a[104:107], v4, s[32:35], s80 offen offset:128 nt
  v_mfma_f32_16x16x32_bf16 v[68:71], a[12:15], v[28:31], v[68:71]
  v_mfma_f32_16x16x32_bf16 v[72:75], a[16:19], v[24:27], 0
  s_waitcnt vmcnt(5)
  buffer_load_dwordx4 a[108:111], v4, s[32:35], s80 offen offset:2176 nt
  v_mfma_f32_16x16x32_bf16 v[76:79], a[20:23], v[24:27], 0
  s_waitcnt vmcnt(5)
  s_mov_b32 s80, 114688
  buffer_load_dwordx4 a[112:115], v4, s[32:35], s80 offen offset:0 nt
  v_mfma_f32_16x16x32_bf16 v[72:75], a[24:27], v[28:31], v[72:75]
  v_mfma_f32_16x16x32_bf16 v[76:79], a[28:31], v[28:31], v[76:79]
  v_add_f32_dpp v124, v65, v64 row_ror:8 row_mask:0xf bank_mask:0x3
  v_add_f32_dpp v125, v67, v66 row_ror:8 row_mask:0xf bank_mask:0x3
  s_nop 0
  v_add_f32_dpp v124, v68, v69 row_ror:8 row_mask:0xf bank_mask:0xc
  v_add_f32_dpp v125, v70, v71 row_ror:8 row_mask:0xf bank_mask:0xc
  v_cvt_pk_bf16_f32 v126, v124, v125
  v_max3_f32 v140, v140, v124, v125
  v_lshlrev_b32 v127, 16, v126
  v_and_b32 v128, 0xffff0000, v126
  v_mul_f32 v127, 1035273459, v127
  v_mul_f32 v128, 1035273459, v128
  v_cvt_pk_bf16_f32 v32, v127, v128
  s_waitcnt vmcnt(5)
  buffer_load_dwordx4 a[116:119], v4, s[32:35], s80 offen offset:2048 nt
  v_mfma_f32_16x16x32_bf16 v[64:67], a[32:35], v[24:27], 0
  s_waitcnt vmcnt(5)
  buffer_load_dwordx4 a[120:123], v4, s[32:35], s80 offen offset:128 nt
  v_mfma_f32_16x16x32_bf16 v[68:71], a[36:39], v[24:27], 0
  v_mfma_f32_16x16x32_bf16 v[64:67], a[40:43], v[28:31], v[64:67]
  s_waitcnt vmcnt(5)
  buffer_load_dwordx4 a[124:127], v4, s[32:35], s80 offen offset:2176 nt
  v_mfma_f32_16x16x32_bf16 v[68:71], a[44:47], v[28:31], v[68:71]
  v_add_f32_dpp v124, v73, v72 row_ror:8 row_mask:0xf bank_mask:0x3
  v_add_f32_dpp v125, v75, v74 row_ror:8 row_mask:0xf bank_mask:0x3
  s_nop 0
  v_add_f32_dpp v124, v76, v77 row_ror:8 row_mask:0xf bank_mask:0xc
  v_add_f32_dpp v125, v78, v79 row_ror:8 row_mask:0xf bank_mask:0xc
  v_cvt_pk_bf16_f32 v126, v124, v125
  v_max3_f32 v140, v140, v124, v125
  v_lshlrev_b32 v127, 16, v126
  v_and_b32 v128, 0xffff0000, v126
  v_mul_f32 v127, 1035273459, v127
  v_mul_f32 v128, 1035273459, v128
  v_cvt_pk_bf16_f32 v33, v127, v128
  s_waitcnt vmcnt(5)
  s_mov_b32 s80, 131072
  buffer_load_dwordx4 a[0:3], v4, s[32:35], s80 offen offset:0 nt
  v_mfma_f32_16x16x32_bf16 v[72:75], a[48:51], v[24:27], 0
  v_mfma_f32_16x16x32_bf16 v[76:79], a[52:55], v[24:27], 0
  s_waitcnt vmcnt(5)
  buffer_load_dwordx4 a[4:7], v4, s[32:35], s80 offen offset:2048 nt
  v_mfma_f32_16x16x32_bf16 v[72:75], a[56:59], v[28:31], v[72:75]
  s_waitcnt vmcnt(5)
  buffer_load_dwordx4 a[8:11], v4, s[32:35], s80 offen offset:128 nt
  v_mfma_f32_16x16x32_bf16 v[76:79], a[60:63], v[28:31], v[76:79]
  v_add_f32_dpp v124, v65, v64 row_ror:8 row_mask:0xf bank_mask:0x3
  v_add_f32_dpp v125, v67, v66 row_ror:8 row_mask:0xf bank_mask:0x3
  s_nop 0
  v_add_f32_dpp v124, v68, v69 row_ror:8 row_mask:0xf bank_mask:0xc
  v_add_f32_dpp v125, v70, v71 row_ror:8 row_mask:0xf bank_mask:0xc
  v_cvt_pk_bf16_f32 v126, v124, v125
  v_max3_f32 v140, v140, v124, v125
  v_lshlrev_b32 v127, 16, v126
  v_and_b32 v128, 0xffff0000, v126
  v_mul_f32 v127, 1035273459, v127
  v_mul_f32 v128, 1035273459, v128
  v_cvt_pk_bf16_f32 v34, v127, v128
  v_mfma_f32_16x16x32_bf16 v[64:67], a[64:67], v[24:27], 0
  s_waitcnt vmcnt(5)
  buffer_load_dwordx4 a[12:15], v4, s[32:35], s80 offen offset:2176 nt
  v_mfma_f32_16x16x32_bf16 v[68:71], a[68:71], v[24:27], 0
  s_waitcnt vmcnt(5)
  s_mov_b32 s80, 147456
  buffer_load_dwordx4 a[16:19], v4, s[32:35], s80 offen offset:0 nt
  v_mfma_f32_16x16x32_bf16 v[64:67], a[72:75], v[28:31], v[64:67]
  v_mfma_f32_16x16x32_bf16 v[68:71], a[76:79], v[28:31], v[68:71]
  v_add_f32_dpp v124, v73, v72 row_ror:8 row_mask:0xf bank_mask:0x3
  v_add_f32_dpp v125, v75, v74 row_ror:8 row_mask:0xf bank_mask:0x3
  s_nop 0
  v_add_f32_dpp v124, v76, v77 row_ror:8 row_mask:0xf bank_mask:0xc
  v_add_f32_dpp v125, v78, v79 row_ror:8 row_mask:0xf bank_mask:0xc
  v_cvt_pk_bf16_f32 v126, v124, v125
  v_max3_f32 v140, v140, v124, v125
  v_lshlrev_b32 v127, 16, v126
  v_and_b32 v128, 0xffff0000, v126
  v_mul_f32 v127, 1035273459, v127
  v_mul_f32 v128, 1035273459, v128
  v_cvt_pk_bf16_f32 v35, v127, v128
  s_waitcnt vmcnt(5)
  buffer_load_dwordx4 a[20:23], v4, s[32:35], s80 offen offset:2048 nt
  v_mfma_f32_16x16x32_bf16 v[72:75], a[80:83], v[24:27], 0
  s_waitcnt vmcnt(5)
  buffer_load_dwordx4 a[24:27], v4, s[32:35], s80 offen offset:128 nt
  v_mfma_f32_16x16x32_bf16 v[76:79], a[84:87], v[24:27], 0
  v_mfma_f32_16x16x32_bf16 v[72:75], a[88:91], v[28:31], v[72:75]
  s_waitcnt vmcnt(5)
  buffer_load_dwordx4 a[28:31], v4, s[32:35], s80 offen offset:2176 nt
  v_mfma_f32_16x16x32_bf16 v[76:79], a[92:95], v[28:31], v[76:79]
  v_add_f32_dpp v124, v65, v64 row_ror:8 row_mask:0xf bank_mask:0x3
  v_add_f32_dpp v125, v67, v66 row_ror:8 row_mask:0xf bank_mask:0x3
  s_nop 0
  v_add_f32_dpp v124, v68, v69 row_ror:8 row_mask:0xf bank_mask:0xc
  v_add_f32_dpp v125, v70, v71 row_ror:8 row_mask:0xf bank_mask:0xc
  v_cvt_pk_bf16_f32 v126, v124, v125
  v_max3_f32 v140, v140, v124, v125
  v_lshlrev_b32 v127, 16, v126
  v_and_b32 v128, 0xffff0000, v126
  v_mul_f32 v127, 1035273459, v127
  v_mul_f32 v128, 1035273459, v128
  v_cvt_pk_bf16_f32 v36, v127, v128
  s_waitcnt vmcnt(5)
  s_mov_b32 s80, 163840
  buffer_load_dwordx4 a[32:35], v4, s[32:35], s80 offen offset:0 nt
  v_mfma_f32_16x16x32_bf16 v[64:67], a[96:99], v[24:27], 0
  v_mfma_f32_16x16x32_bf16 v[68:71], a[100:103], v[24:27], 0
  s_waitcnt vmcnt(5)
  buffer_load_dwordx4 a[36:39], v4, s[32:35], s80 offen offset:2048 nt
  v_mfma_f32_16x16x32_bf16 v[64:67], a[104:107], v[28:31], v[64:67]
  s_waitcnt vmcnt(5)
  buffer_load_dwordx4 a[40:43], v4, s[32:35], s80 offen offset:128 nt
  v_mfma_f32_16x16x32_bf16 v[68:71], a[108:111], v[28:31], v[68:71]
  v_add_f32_dpp v124, v73, v72 row_ror:8 row_mask:0xf bank_mask:0x3
  v_add_f32_dpp v125, v75, v74 row_ror:8 row_mask:0xf bank_mask:0x3
  s_nop 0
  v_add_f32_dpp v124, v76, v77 row_ror:8 row_mask:0xf bank_mask:0xc
  v_add_f32_dpp v125, v78, v79 row_ror:8 row_mask:0xf bank_mask:0xc
  v_cvt_pk_bf16_f32 v126, v124, v125
  v_max3_f32 v140, v140, v124, v125
  v_lshlrev_b32 v127, 16, v126
  v_and_b32 v128, 0xffff0000, v126
  v_mul_f32 v127, 1035273459, v127
  v_mul_f32 v128, 1035273459, v128
  v_cvt_pk_bf16_f32 v37, v127, v128
  v_mfma_f32_16x16x32_bf16 v[72:75], a[112:115], v[24:27], 0
  s_waitcnt vmcnt(5)
  buffer_load_dwordx4 a[44:47], v4, s[32:35], s80 offen offset:2176 nt
  v_mfma_f32_16x16x32_bf16 v[76:79], a[116:119], v[24:27], 0
  s_waitcnt vmcnt(5)
  s_mov_b32 s80, 180224
  buffer_load_dwordx4 a[48:51], v4, s[32:35], s80 offen offset:0 nt
  v_mfma_f32_16x16x32_bf16 v[72:75], a[120:123], v[28:31], v[72:75]
  v_mfma_f32_16x16x32_bf16 v[76:79], a[124:127], v[28:31], v[76:79]
  v_add_f32_dpp v124, v65, v64 row_ror:8 row_mask:0xf bank_mask:0x3
  v_add_f32_dpp v125, v67, v66 row_ror:8 row_mask:0xf bank_mask:0x3
  s_nop 0
  v_add_f32_dpp v124, v68, v69 row_ror:8 row_mask:0xf bank_mask:0xc
  v_add_f32_dpp v125, v70, v71 row_ror:8 row_mask:0xf bank_mask:0xc
  v_cvt_pk_bf16_f32 v126, v124, v125
  v_max3_f32 v140, v140, v124, v125
  v_lshlrev_b32 v127, 16, v126
  v_and_b32 v128, 0xffff0000, v126
  v_mul_f32 v127, 1035273459, v127
  v_mul_f32 v128, 1035273459, v128
  v_cvt_pk_bf16_f32 v38, v127, v128
  s_waitcnt vmcnt(5)
  buffer_load_dwordx4 a[52:55], v4, s[32:35], s80 offen offset:2048 nt
  v_mfma_f32_16x16x32_bf16 v[64:67], a[0:3], v[24:27], 0
  s_waitcnt vmcnt(5)
  buffer_load_dwordx4 a[56:59], v4, s[32:35], s80 offen offset:128 nt
  v_mfma_f32_16x16x32_bf16 v[68:71], a[4:7], v[24:27], 0
  v_mfma_f32_16x16x32_bf16 v[64:67], a[8:11], v[28:31], v[64:67]
  s_waitcnt vmcnt(5)
  buffer_load_dwordx4 a[60:63], v4, s[32:35], s80 offen offset:2176 nt
  v_mfma_f32_16x16x32_bf16 v[68:71], a[12:15], v[28:31], v[68:71]
  v_add_f32_dpp v124, v73, v72 row_ror:8 row_mask:0xf bank_mask:0x3
  v_add_f32_dpp v125, v75, v74 row_ror:8 row_mask:0xf bank_mask:0x3
  s_nop 0
  v_add_f32_dpp v124, v76, v77 row_ror:8 row_mask:0xf bank_mask:0xc
  v_add_f32_dpp v125, v78, v79 row_ror:8 row_mask:0xf bank_mask:0xc
  v_cvt_pk_bf16_f32 v126, v124, v125
  v_max3_f32 v140, v140, v124, v125
  v_lshlrev_b32 v127, 16, v126
  v_and_b32 v128, 0xffff0000, v126
  v_mul_f32 v127, 1035273459, v127
  v_mul_f32 v128, 1035273459, v128
  v_cvt_pk_bf16_f32 v39, v127, v128
  s_waitcnt vmcnt(5)
  s_mov_b32 s80, 196608
  buffer_load_dwordx4 a[64:67], v4, s[32:35], s80 offen offset:0 nt
  v_mfma_f32_16x16x32_bf16 v[72:75], a[16:19], v[24:27], 0
  v_mfma_f32_16x16x32_bf16 v[76:79], a[20:23], v[24:27], 0
  s_waitcnt vmcnt(5)
  buffer_load_dwordx4 a[68:71], v4, s[32:35], s80 offen offset:2048 nt
  v_mfma_f32_16x16x32_bf16 v[72:75], a[24:27], v[28:31], v[72:75]
  s_waitcnt vmcnt(5)
  buffer_load_dwordx4 a[72:75], v4, s[32:35], s80 offen offset:128 nt
  v_mfma_f32_16x16x32_bf16 v[76:79], a[28:31], v[28:31], v[76:79]
  v_add_f32_dpp v124, v65, v64 row_ror:8 row_mask:0xf bank_mask:0x3
  v_add_f32_dpp v125, v67, v66 row_ror:8 row_mask:0xf bank_mask:0x3
  s_nop 0
  v_add_f32_dpp v124, v68, v69 row_ror:8 row_mask:0xf bank_mask:0xc
  v_add_f32_dpp v125, v70, v71 row_ror:8 row_mask:0xf bank_mask:0xc
  v_cvt_pk_bf16_f32 v126, v124, v125
  v_max3_f32 v140, v140, v124, v125
  v_lshlrev_b32 v127, 16, v126
  v_and_b32 v128, 0xffff0000, v126
  v_mul_f32 v127, 1035273459, v127
  v_mul_f32 v128, 1035273459, v128
  v_cvt_pk_bf16_f32 v40, v127, v128
  v_mfma_f32_16x16x32_bf16 v[64:67], a[32:35], v[24:27], 0
  s_waitcnt vmcnt(5)
  buffer_load_dwordx4 a[76:79], v4, s[32:35], s80 offen offset:2176 nt
  v_mfma_f32_16x16x32_bf16 v[68:71], a[36:39], v[24:27], 0
  s_waitcnt vmcnt(5)
  s_mov_b32 s80, 212992
  buffer_load_dwordx4 a[80:83], v4, s[32:35], s80 offen offset:0 nt
  v_mfma_f32_16x16x32_bf16 v[64:67], a[40:43], v[28:31], v[64:67]
  v_mfma_f32_16x16x32_bf16 v[68:71], a[44:47], v[28:31], v[68:71]
  v_add_f32_dpp v124, v73, v72 row_ror:8 row_mask:0xf bank_mask:0x3
  v_add_f32_dpp v125, v75, v74 row_ror:8 row_mask:0xf bank_mask:0x3
  s_nop 0
  v_add_f32_dpp v124, v76, v77 row_ror:8 row_mask:0xf bank_mask:0xc
  v_add_f32_dpp v125, v78, v79 row_ror:8 row_mask:0xf bank_mask:0xc
  v_cvt_pk_bf16_f32 v126, v124, v125
  v_max3_f32 v140, v140, v124, v125
  v_lshlrev_b32 v127, 16, v126
  v_and_b32 v128, 0xffff0000, v126
  v_mul_f32 v127, 1035273459, v127
  v_mul_f32 v128, 1035273459, v128
  v_cvt_pk_bf16_f32 v41, v127, v128
  s_waitcnt vmcnt(5)
  buffer_load_dwordx4 a[84:87], v4, s[32:35], s80 offen offset:2048 nt
  v_mfma_f32_16x16x32_bf16 v[72:75], a[48:51], v[24:27], 0
  s_waitcnt vmcnt(5)
  buffer_load_dwordx4 a[88:91], v4, s[32:35], s80 offen offset:128 nt
  v_mfma_f32_16x16x32_bf16 v[76:79], a[52:55], v[24:27], 0
  v_mfma_f32_16x16x32_bf16 v[72:75], a[56:59], v[28:31], v[72:75]
  s_waitcnt vmcnt(5)
  buffer_load_dwordx4 a[92:95], v4, s[32:35], s80 offen offset:2176 nt
  v_mfma_f32_16x16x32_bf16 v[76:79], a[60:63], v[28:31], v[76:79]
  v_add_f32_dpp v124, v65, v64 row_ror:8 row_mask:0xf bank_mask:0x3
  v_add_f32_dpp v125, v67, v66 row_ror:8 row_mask:0xf bank_mask:0x3
  s_nop 0
  v_add_f32_dpp v124, v68, v69 row_ror:8 row_mask:0xf bank_mask:0xc
  v_add_f32_dpp v125, v70, v71 row_ror:8 row_mask:0xf bank_mask:0xc
  v_cvt_pk_bf16_f32 v126, v124, v125
  v_max3_f32 v140, v140, v124, v125
  v_lshlrev_b32 v127, 16, v126
  v_and_b32 v128, 0xffff0000, v126
  v_mul_f32 v127, 1035273459, v127
  v_mul_f32 v128, 1035273459, v128
  v_cvt_pk_bf16_f32 v42, v127, v128
  s_waitcnt vmcnt(5)
  s_mov_b32 s80, 229376
  buffer_load_dwordx4 a[96:99], v4, s[32:35], s80 offen offset:0 nt
  v_mfma_f32_16x16x32_bf16 v[64:67], a[64:67], v[24:27], 0
  v_mfma_f32_16x16x32_bf16 v[68:71], a[68:71], v[24:27], 0
  s_waitcnt vmcnt(5)
  buffer_load_dwordx4 a[100:103], v4, s[32:35], s80 offen offset:2048 nt
  v_mfma_f32_16x16x32_bf16 v[64:67], a[72:75], v[28:31], v[64:67]
  s_waitcnt vmcnt(5)
  buffer_load_dwordx4 a[104:107], v4, s[32:35], s80 offen offset:128 nt
  v_mfma_f32_16x16x32_bf16 v[68:71], a[76:79], v[28:31], v[68:71]
  s_mov_b32 s81, 0
  buffer_load_dwordx4 a[128:131], v7, s[44:47], s81 offen offset:0
  buffer_load_dwordx4 a[144:147], v7, s[44:47], s81 offen offset:1024
  v_add_f32_dpp v124, v73, v72 row_ror:8 row_mask:0xf bank_mask:0x3
  v_add_f32_dpp v125, v75, v74 row_ror:8 row_mask:0xf bank_mask:0x3
  s_nop 0
  v_add_f32_dpp v124, v76, v77 row_ror:8 row_mask:0xf bank_mask:0xc
  v_add_f32_dpp v125, v78, v79 row_ror:8 row_mask:0xf bank_mask:0xc
  v_cvt_pk_bf16_f32 v126, v124, v125
  v_max3_f32 v140, v140, v124, v125
  v_lshlrev_b32 v127, 16, v126
  v_and_b32 v128, 0xffff0000, v126
  v_mul_f32 v127, 1035273459, v127
  v_mul_f32 v128, 1035273459, v128
  v_cvt_pk_bf16_f32 v43, v127, v128
  v_mfma_f32_16x16x32_bf16 v[72:75], a[80:83], v[24:27], 0
  s_waitcnt vmcnt(7)
  buffer_load_dwordx4 a[108:111], v4, s[32:35], s80 offen offset:2176 nt
  v_mfma_f32_16x16x32_bf16 v[76:79], a[84:87], v[24:27], 0
  s_waitcnt vmcnt(7)
  s_mov_b32 s80, 245760
  buffer_load_dwordx4 a[112:115], v4, s[32:35], s80 offen offset:0 nt
  v_mfma_f32_16x16x32_bf16 v[72:75], a[88:91], v[28:31], v[72:75]
  s_waitcnt vmcnt(7)
  v_mfma_f32_16x16x32_bf16 v[76:79], a[92:95], v[28:31], v[76:79]
  s_mov_b32 s81, 8192
  buffer_load_dwordx4 a[132:135], v7, s[44:47], s81 offen offset:0
  buffer_load_dwordx4 a[148:151], v7, s[44:47], s81 offen offset:1024
  v_add_f32_dpp v124, v65, v64 row_ror:8 row_mask:0xf bank_mask:0x3
  v_add_f32_dpp v125, v67, v66 row_ror:8 row_mask:0xf bank_mask:0x3
  s_nop 0
  v_add_f32_dpp v124, v68, v69 row_ror:8 row_mask:0xf bank_mask:0xc
  v_add_f32_dpp v125, v70, v71 row_ror:8 row_mask:0xf bank_mask:0xc
  v_cvt_pk_bf16_f32 v126, v124, v125
  v_max3_f32 v140, v140, v124, v125
  v_lshlrev_b32 v127, 16, v126
  v_and_b32 v128, 0xffff0000, v126
  v_mul_f32 v127, 1035273459, v127
  v_mul_f32 v128, 1035273459, v128
  v_cvt_pk_bf16_f32 v44, v127, v128
  s_waitcnt vmcnt(8)
  buffer_load_dwordx4 a[116:119], v4, s[32:35], s80 offen offset:2048 nt
  v_mfma_f32_16x16x32_bf16 v[64:67], a[96:99], v[24:27], 0
  s_waitcnt vmcnt(8)
  buffer_load_dwordx4 a[120:123], v4, s[32:35], s80 offen offset:128 nt
  v_mfma_f32_16x16x32_bf16 v[68:71], a[100:103], v[24:27], 0
  s_waitcnt vmcnt(8)
  buffer_load_dwordx4 a[124:127], v4, s[32:35], s80 offen offset:2176 nt
  v_mfma_f32_16x16x32_bf16 v[64:67], a[104:107], v[28:31], v[64:67]
  s_waitcnt vmcnt(6)
  s_mov_b32 s80, 262144
  buffer_load_dwordx4 a[0:3], v4, s[32:35], s80 offen offset:0 nt
  v_mfma_f32_16x16x32_bf16 v[68:71], a[108:111], v[28:31], v[68:71]
  s_mov_b32 s81, 16384
  buffer_load_dwordx4 a[136:139], v7, s[44:47], s81 offen offset:0
  buffer_load_dwordx4 a[152:155], v7, s[44:47], s81 offen offset:1024
  v_add_f32_dpp v124, v73, v72 row_ror:8 row_mask:0xf bank_mask:0x3
  v_add_f32_dpp v125, v75, v74 row_ror:8 row_mask:0xf bank_mask:0x3
  s_nop 0
  v_add_f32_dpp v124, v76, v77 row_ror:8 row_mask:0xf bank_mask:0xc
  v_add_f32_dpp v125, v78, v79 row_ror:8 row_mask:0xf bank_mask:0xc
  v_cvt_pk_bf16_f32 v126, v124, v125
  v_max3_f32 v140, v140, v124, v125
  v_lshlrev_b32 v127, 16, v126
  v_and_b32 v128, 0xffff0000, v126
  v_mul_f32 v127, 1035273459, v127
  v_mul_f32 v128, 1035273459, v128
  v_cvt_pk_bf16_f32 v45, v127, v128
  s_waitcnt vmcnt(8)
  buffer_load_dwordx4 a[4:7], v4, s[32:35], s80 offen offset:2048 nt
  v_mfma_f32_16x16x32_bf16 v[72:75], a[112:115], v[24:27], 0
  s_waitcnt vmcnt(6)
  buffer_load_dwordx4 a[8:11], v4, s[32:35], s80 offen offset:128 nt
  v_mfma_f32_16x16x32_bf16 v[76:79], a[116:119], v[24:27], 0
  s_waitcnt vmcnt(6)
  buffer_load_dwordx4 a[12:15], v4, s[32:35], s80 offen offset:2176 nt
  v_mfma_f32_16x16x32_bf16 v[72:75], a[120:123], v[28:31], v[72:75]
  s_waitcnt vmcnt(6)
  s_mov_b32 s80, 278528
  buffer_load_dwordx4 a[16:19], v4, s[32:35], s80 offen offset:0 nt
  v_mfma_f32_16x16x32_bf16 v[76:79], a[124:127], v[28:31], v[76:79]
  s_mov_b32 s81, 24576
  buffer_load_dwordx4 a[140:143], v7, s[44:47], s81 offen offset:0
  buffer_load_dwordx4 a[156:159], v7, s[44:47], s81 offen offset:1024
  v_add_f32_dpp v124, v65, v64 row_ror:8 row_mask:0xf bank_mask:0x3
  v_add_f32_dpp v125, v67, v66 row_ror:8 row_mask:0xf bank_mask:0x3
  s_nop 0
  v_add_f32_dpp v124, v68, v69 row_ror:8 row_mask:0xf bank_mask:0xc
  v_add_f32_dpp v125, v70, v71 row_ror:8 row_mask:0xf bank_mask:0xc
  v_cvt_pk_bf16_f32 v126, v124, v125
  v_max3_f32 v140, v140, v124, v125
  v_lshlrev_b32 v127, 16, v126
  v_and_b32 v128, 0xffff0000, v126
  v_mul_f32 v127, 1035273459, v127
  v_mul_f32 v128, 1035273459, v128
  v_cvt_pk_bf16_f32 v46, v127, v128
  s_waitcnt vmcnt(8)
  buffer_load_dwordx4 a[20:23], v4, s[32:35], s80 offen offset:2048 nt
  v_mfma_f32_16x16x32_bf16 v[64:67], a[0:3], v[24:27], 0
  s_waitcnt vmcnt(6)
  buffer_load_dwordx4 a[24:27], v4, s[32:35], s80 offen offset:128 nt
  v_mfma_f32_16x16x32_bf16 v[68:71], a[4:7], v[24:27], 0
  s_waitcnt vmcnt(6)
  buffer_load_dwordx4 a[28:31], v4, s[32:35], s80 offen offset:2176 nt
  v_mfma_f32_16x16x32_bf16 v[64:67], a[8:11], v[28:31], v[64:67]
  s_waitcnt vmcnt(6)
  s_mov_b32 s80, 294912
  buffer_load_dwordx4 a[32:35], v4, s[32:35], s80 offen offset:0 nt
  v_mfma_f32_16x16x32_bf16 v[68:71], a[12:15], v[28:31], v[68:71]
  s_mov_b32 s81, 32768
  buffer_load_dwordx4 a[160:163], v7, s[44:47], s81 offen offset:0
  buffer_load_dwordx4 a[176:179], v7, s[44:47], s81 offen offset:1024
  v_add_f32_dpp v124, v73, v72 row_ror:8 row_mask:0xf bank_mask:0x3
  v_add_f32_dpp v125, v75, v74 row_ror:8 row_mask:0xf bank_mask:0x3
  s_nop 0
  v_add_f32_dpp v124, v76, v77 row_ror:8 row_mask:0xf bank_mask:0xc
  v_add_f32_dpp v125, v78, v79 row_ror:8 row_mask:0xf bank_mask:0xc
  v_cvt_pk_bf16_f32 v126, v124, v125
  v_max3_f32 v140, v140, v124, v125
  v_lshlrev_b32 v127, 16, v126
  v_and_b32 v128, 0xffff0000, v126
  v_mul_f32 v127, 1035273459, v127
  v_mul_f32 v128, 1035273459, v128
  v_cvt_pk_bf16_f32 v47, v127, v128
  s_waitcnt vmcnt(8)
  buffer_load_dwordx4 a[36:39], v4, s[32:35], s80 offen offset:2048 nt
  v_mfma_f32_16x16x32_bf16 v[72:75], a[16:19], v[24:27], 0
  s_waitcnt vmcnt(6)
  buffer_load_dwordx4 a[40:43], v4, s[32:35], s80 offen offset:128 nt
  v_mfma_f32_16x16x32_bf16 v[76:79], a[20:23], v[24:27], 0
  s_waitcnt vmcnt(6)
  buffer_load_dwordx4 a[44:47], v4, s[32:35], s80 offen offset:2176 nt
  v_mfma_f32_16x16x32_bf16 v[72:75], a[24:27], v[28:31], v[72:75]
  s_waitcnt vmcnt(6)
  s_mov_b32 s80, 311296
  buffer_load_dwordx4 a[48:51], v4, s[32:35], s80 offen offset:0 nt
  v_mfma_f32_16x16x32_bf16 v[76:79], a[28:31], v[28:31], v[76:79]
  s_mov_b32 s81, 40960
  buffer_load_dwordx4 a[164:167], v7, s[44:47], s81 offen offset:0
  buffer_load_dwordx4 a[180:183], v7, s[44:47], s81 offen offset:1024
  v_add_f32_dpp v124, v65, v64 row_ror:8 row_mask:0xf bank_mask:0x3
  v_add_f32_dpp v125, v67, v66 row_ror:8 row_mask:0xf bank_mask:0x3
  s_nop 0
  v_add_f32_dpp v124, v68, v69 row_ror:8 row_mask:0xf bank_mask:0xc
  v_add_f32_dpp v125, v70, v71 row_ror:8 row_mask:0xf bank_mask:0xc
  v_cvt_pk_bf16_f32 v126, v124, v125
  v_max3_f32 v140, v140, v124, v125
  v_lshlrev_b32 v127, 16, v126
  v_and_b32 v128, 0xffff0000, v126
  v_mul_f32 v127, 1035273459, v127
  v_mul_f32 v128, 1035273459, v128
  v_cvt_pk_bf16_f32 v48, v127, v128
  s_waitcnt vmcnt(8)
  buffer_load_dwordx4 a[52:55], v4, s[32:35], s80 offen offset:2048 nt
  v_mfma_f32_16x16x32_bf16 v[64:67], a[32:35], v[24:27], 0
  s_waitcnt vmcnt(6)
  buffer_load_dwordx4 a[56:59], v4, s[32:35], s80 offen offset:128 nt
  v_mfma_f32_16x16x32_bf16 v[68:71], a[36:39], v[24:27], 0
  s_waitcnt vmcnt(6)
  buffer_load_dwordx4 a[60:63], v4, s[32:35], s80 offen offset:2176 nt
  v_mfma_f32_16x16x32_bf16 v[64:67], a[40:43], v[28:31], v[64:67]
  s_waitcnt vmcnt(6)
  s_mov_b32 s80, 327680
  buffer_load_dwordx4 a[64:67], v4, s[32:35], s80 offen offset:0 nt
  v_mfma_f32_16x16x32_bf16 v[68:71], a[44:47], v[28:31], v[68:71]
  s_mov_b32 s81, 49152
  buffer_load_dwordx4 a[168:171], v7, s[44:47], s81 offen offset:0
  buffer_load_dwordx4 a[184:187], v7, s[44:47], s81 offen offset:1024
  v_add_f32_dpp v124, v73, v72 row_ror:8 row_mask:0xf bank_mask:0x3
  v_add_f32_dpp v125, v75, v74 row_ror:8 row_mask:0xf bank_mask:0x3
  s_nop 0
  v_add_f32_dpp v124, v76, v77 row_ror:8 row_mask:0xf bank_mask:0xc
  v_add_f32_dpp v125, v78, v79 row_ror:8 row_mask:0xf bank_mask:0xc
  v_cvt_pk_bf16_f32 v126, v124, v125
  v_max3_f32 v140, v140, v124, v125
  v_lshlrev_b32 v127, 16, v126
  v_and_b32 v128, 0xffff0000, v126
  v_mul_f32 v127, 1035273459, v127
  v_mul_f32 v128, 1035273459, v128
  v_cvt_pk_bf16_f32 v49, v127, v128
  s_waitcnt vmcnt(8)
  buffer_load_dwordx4 a[68:71], v4, s[32:35], s80 offen offset:2048 nt
  v_mfma_f32_16x16x32_bf16 v[72:75], a[48:51], v[24:27], 0
  s_waitcnt vmcnt(6)
  buffer_load_dwordx4 a[72:75], v4, s[32:35], s80 offen offset:128 nt
  v_mfma_f32_16x16x32_bf16 v[76:79], a[52:55], v[24:27], 0
  s_waitcnt vmcnt(6)
  buffer_load_dwordx4 a[76:79], v4, s[32:35], s80 offen offset:2176 nt
  v_mfma_f32_16x16x32_bf16 v[72:75], a[56:59], v[28:31], v[72:75]
  s_waitcnt vmcnt(6)
  s_mov_b32 s80, 344064
  buffer_load_dwordx4 a[80:83], v4, s[32:35], s80 offen offset:0 nt
  v_mfma_f32_16x16x32_bf16 v[76:79], a[60:63], v[28:31], v[76:79]
  s_mov_b32 s81, 57344
  buffer_load_dwordx4 a[172:175], v7, s[44:47], s81 offen offset:0
  buffer_load_dwordx4 a[188:191], v7, s[44:47], s81 offen offset:1024
  v_add_f32_dpp v124, v65, v64 row_ror:8 row_mask:0xf bank_mask:0x3
  v_add_f32_dpp v125, v67, v66 row_ror:8 row_mask:0xf bank_mask:0x3
  s_nop 0
  v_add_f32_dpp v124, v68, v69 row_ror:8 row_mask:0xf bank_mask:0xc
  v_add_f32_dpp v125, v70, v71 row_ror:8 row_mask:0xf bank_mask:0xc
  v_cvt_pk_bf16_f32 v126, v124, v125
  v_max3_f32 v140, v140, v124, v125
  v_lshlrev_b32 v127, 16, v126
  v_and_b32 v128, 0xffff0000, v126
  v_mul_f32 v127, 1035273459, v127
  v_mul_f32 v128, 1035273459, v128
  v_cvt_pk_bf16_f32 v50, v127, v128
  s_waitcnt vmcnt(8)
  buffer_load_dwordx4 a[84:87], v4, s[32:35], s80 offen offset:2048 nt
  v_mfma_f32_16x16x32_bf16 v[64:67], a[64:67], v[24:27], 0
  s_waitcnt vmcnt(6)
  buffer_load_dwordx4 a[88:91], v4, s[32:35], s80 offen offset:128 nt
  v_mfma_f32_16x16x32_bf16 v[68:71], a[68:71], v[24:27], 0
  s_waitcnt vmcnt(6)
  buffer_load_dwordx4 a[92:95], v4, s[32:35], s80 offen offset:2176 nt
  v_mfma_f32_16x16x32_bf16 v[64:67], a[72:75], v[28:31], v[64:67]
  s_waitcnt vmcnt(6)
  s_mov_b32 s80, 360448
  buffer_load_dwordx4 a[96:99], v4, s[32:35], s80 offen offset:0 nt
  v_mfma_f32_16x16x32_bf16 v[68:71], a[76:79], v[28:31], v[68:71]
  s_mov_b32 s81, 65536
  buffer_load_dwordx4 a[192:195], v7, s[44:47], s81 offen offset:0
  buffer_load_dwordx4 a[208:211], v7, s[44:47], s81 offen offset:1024
  v_add_f32_dpp v124, v73, v72 row_ror:8 row_mask:0xf bank_mask:0x3
  v_add_f32_dpp v125, v75, v74 row_ror:8 row_mask:0xf bank_mask:0x3
  s_nop 0
  v_add_f32_dpp v124, v76, v77 row_ror:8 row_mask:0xf bank_mask:0xc
  v_add_f32_dpp v125, v78, v79 row_ror:8 row_mask:0xf bank_mask:0xc
  v_cvt_pk_bf16_f32 v126, v124, v125
  v_max3_f32 v140, v140, v124, v125
  v_lshlrev_b32 v127, 16, v126
  v_and_b32 v128, 0xffff0000, v126
  v_mul_f32 v127, 1035273459, v127
  v_mul_f32 v128, 1035273459, v128
  v_cvt_pk_bf16_f32 v51, v127, v128
  s_waitcnt vmcnt(8)
  buffer_load_dwordx4 a[100:103], v4, s[32:35], s80 offen offset:2048 nt
  v_mfma_f32_16x16x32_bf16 v[72:75], a[80:83], v[24:27], 0
  s_waitcnt vmcnt(6)
  buffer_load_dwordx4 a[104:107], v4, s[32:35], s80 offen offset:128 nt
  v_mfma_f32_16x16x32_bf16 v[76:79], a[84:87], v[24:27], 0
  s_waitcnt vmcnt(6)
  buffer_load_dwordx4 a[108:111], v4, s[32:35], s80 offen offset:2176 nt
  v_mfma_f32_16x16x32_bf16 v[72:75], a[88:91], v[28:31], v[72:75]
  s_waitcnt vmcnt(6)
  s_mov_b32 s80, 376832
  buffer_load_dwordx4 a[112:115], v4, s[32:35], s80 offen offset:0 nt
  v_mfma_f32_16x16x32_bf16 v[76:79], a[92:95], v[28:31], v[76:79]
  s_mov_b32 s81, 73728
  buffer_load_dwordx4 a[196:199], v7, s[44:47], s81 offen offset:0
  buffer_load_dwordx4 a[212:215], v7, s[44:47], s81 offen offset:1024
  v_add_f32_dpp v124, v65, v64 row_ror:8 row_mask:0xf bank_mask:0x3
  v_add_f32_dpp v125, v67, v66 row_ror:8 row_mask:0xf bank_mask:0x3
  s_nop 0
  v_add_f32_dpp v124, v68, v69 row_ror:8 row_mask:0xf bank_mask:0xc
  v_add_f32_dpp v125, v70, v71 row_ror:8 row_mask:0xf bank_mask:0xc
  v_cvt_pk_bf16_f32 v126, v124, v125
  v_max3_f32 v140, v140, v124, v125
  v_lshlrev_b32 v127, 16, v126
  v_and_b32 v128, 0xffff0000, v126
  v_mul_f32 v127, 1035273459, v127
  v_mul_f32 v128, 1035273459, v128
  v_cvt_pk_bf16_f32 v52, v127, v128
  s_waitcnt vmcnt(8)
  buffer_load_dwordx4 a[116:119], v4, s[32:35], s80 offen offset:2048 nt
  v_mfma_f32_16x16x32_bf16 v[64:67], a[96:99], v[24:27], 0
  s_waitcnt vmcnt(6)
  buffer_load_dwordx4 a[120:123], v4, s[32:35], s80 offen offset:128 nt
  v_mfma_f32_16x16x32_bf16 v[68:71], a[100:103], v[24:27], 0
  s_waitcnt vmcnt(6)
  buffer_load_dwordx4 a[124:127], v4, s[32:35], s80 offen offset:2176 nt
  v_mfma_f32_16x16x32_bf16 v[64:67], a[104:107], v[28:31], v[64:67]
  s_waitcnt vmcnt(6)
  s_mov_b32 s80, 393216
  buffer_load_dwordx4 a[0:3], v4, s[32:35], s80 offen offset:0 nt
  v_mfma_f32_16x16x32_bf16 v[68:71], a[108:111], v[28:31], v[68:71]
  s_mov_b32 s81, 81920
  buffer_load_dwordx4 a[200:203], v7, s[44:47], s81 offen offset:0
  buffer_load_dwordx4 a[216:219], v7, s[44:47], s81 offen offset:1024
  v_add_f32_dpp v124, v73, v72 row_ror:8 row_mask:0xf bank_mask:0x3
  v_add_f32_dpp v125, v75, v74 row_ror:8 row_mask:0xf bank_mask:0x3
  s_nop 0
  v_add_f32_dpp v124, v76, v77 row_ror:8 row_mask:0xf bank_mask:0xc
  v_add_f32_dpp v125, v78, v79 row_ror:8 row_mask:0xf bank_mask:0xc
  v_cvt_pk_bf16_f32 v126, v124, v125
  v_max3_f32 v140, v140, v124, v125
  v_lshlrev_b32 v127, 16, v126
  v_and_b32 v128, 0xffff0000, v126
  v_mul_f32 v127, 1035273459, v127
  v_mul_f32 v128, 1035273459, v128
  v_cvt_pk_bf16_f32 v53, v127, v128
  s_waitcnt vmcnt(8)
  buffer_load_dwordx4 a[4:7], v4, s[32:35], s80 offen offset:2048 nt
  v_mfma_f32_16x16x32_bf16 v[72:75], a[112:115], v[24:27], 0
  s_waitcnt vmcnt(6)
  buffer_load_dwordx4 a[8:11], v4, s[32:35], s80 offen offset:128 nt
  v_mfma_f32_16x16x32_bf16 v[76:79], a[116:119], v[24:27], 0
  s_waitcnt vmcnt(6)
  buffer_load_dwordx4 a[12:15], v4, s[32:35], s80 offen offset:2176 nt
  v_mfma_f32_16x16x32_bf16 v[72:75], a[120:123], v[28:31], v[72:75]
  s_waitcnt vmcnt(6)
  s_mov_b32 s80, 409600
  buffer_load_dwordx4 a[16:19], v4, s[32:35], s80 offen offset:0 nt
  v_mfma_f32_16x16x32_bf16 v[76:79], a[124:127], v[28:31], v[76:79]
  s_mov_b32 s81, 90112
  buffer_load_dwordx4 a[204:207], v7, s[44:47], s81 offen offset:0
  buffer_load_dwordx4 a[220:223], v7, s[44:47], s81 offen offset:1024
  v_add_f32_dpp v124, v65, v64 row_ror:8 row_mask:0xf bank_mask:0x3
  v_add_f32_dpp v125, v67, v66 row_ror:8 row_mask:0xf bank_mask:0x3
  s_nop 0
  v_add_f32_dpp v124, v68, v69 row_ror:8 row_mask:0xf bank_mask:0xc
  v_add_f32_dpp v125, v70, v71 row_ror:8 row_mask:0xf bank_mask:0xc
  v_cvt_pk_bf16_f32 v126, v124, v125
  v_max3_f32 v140, v140, v124, v125
  v_lshlrev_b32 v127, 16, v126
  v_and_b32 v128, 0xffff0000, v126
  v_mul_f32 v127, 1035273459, v127
  v_mul_f32 v128, 1035273459, v128
  v_cvt_pk_bf16_f32 v54, v127, v128
  s_waitcnt vmcnt(8)
  buffer_load_dwordx4 a[20:23], v4, s[32:35], s80 offen offset:2048 nt
  v_mfma_f32_16x16x32_bf16 v[64:67], a[0:3], v[24:27], 0
  s_waitcnt vmcnt(6)
  buffer_load_dwordx4 a[24:27], v4, s[32:35], s80 offen offset:128 nt
  v_mfma_f32_16x16x32_bf16 v[68:71], a[4:7], v[24:27], 0
  s_waitcnt vmcnt(6)
  buffer_load_dwordx4 a[28:31], v4, s[32:35], s80 offen offset:2176 nt
  v_mfma_f32_16x16x32_bf16 v[64:67], a[8:11], v[28:31], v[64:67]
  s_waitcnt vmcnt(6)
  s_mov_b32 s80, 425984
  buffer_load_dwordx4 a[32:35], v4, s[32:35], s80 offen offset:0 nt
  v_mfma_f32_16x16x32_bf16 v[68:71], a[12:15], v[28:31], v[68:71]
  s_mov_b32 s81, 98304
  buffer_load_dwordx4 a[224:227], v7, s[44:47], s81 offen offset:0
  buffer_load_dwordx4 a[240:243], v7, s[44:47], s81 offen offset:1024
  v_add_f32_dpp v124, v73, v72 row_ror:8 row_mask:0xf bank_mask:0x3
  v_add_f32_dpp v125, v75, v74 row_ror:8 row_mask:0xf bank_mask:0x3
  s_nop 0
  v_add_f32_dpp v124, v76, v77 row_ror:8 row_mask:0xf bank_mask:0xc
  v_add_f32_dpp v125, v78, v79 row_ror:8 row_mask:0xf bank_mask:0xc
  v_cvt_pk_bf16_f32 v126, v124, v125
  v_max3_f32 v140, v140, v124, v125
  v_lshlrev_b32 v127, 16, v126
  v_and_b32 v128, 0xffff0000, v126
  v_mul_f32 v127, 1035273459, v127
  v_mul_f32 v128, 1035273459, v128
  v_cvt_pk_bf16_f32 v55, v127, v128
  s_waitcnt vmcnt(8)
  buffer_load_dwordx4 a[36:39], v4, s[32:35], s80 offen offset:2048 nt
  v_mfma_f32_16x16x32_bf16 v[72:75], a[16:19], v[24:27], 0
  s_waitcnt vmcnt(6)
  buffer_load_dwordx4 a[40:43], v4, s[32:35], s80 offen offset:128 nt
  v_mfma_f32_16x16x32_bf16 v[76:79], a[20:23], v[24:27], 0
  s_waitcnt vmcnt(6)
  buffer_load_dwordx4 a[44:47], v4, s[32:35], s80 offen offset:2176 nt
  v_mfma_f32_16x16x32_bf16 v[72:75], a[24:27], v[28:31], v[72:75]
  s_waitcnt vmcnt(6)
  s_mov_b32 s80, 442368
  buffer_load_dwordx4 a[48:51], v4, s[32:35], s80 offen offset:0 nt
  v_mfma_f32_16x16x32_bf16 v[76:79], a[28:31], v[28:31], v[76:79]
  s_mov_b32 s81, 106496
  buffer_load_dwordx4 a[228:231], v7, s[44:47], s81 offen offset:0
  buffer_load_dwordx4 a[244:247], v7, s[44:47], s81 offen offset:1024
  v_add_f32_dpp v124, v65, v64 row_ror:8 row_mask:0xf bank_mask:0x3
  v_add_f32_dpp v125, v67, v66 row_ror:8 row_mask:0xf bank_mask:0x3
  s_nop 0
  v_add_f32_dpp v124, v68, v69 row_ror:8 row_mask:0xf bank_mask:0xc
  v_add_f32_dpp v125, v70, v71 row_ror:8 row_mask:0xf bank_mask:0xc
  v_cvt_pk_bf16_f32 v126, v124, v125
  v_max3_f32 v140, v140, v124, v125
  v_lshlrev_b32 v127, 16, v126
  v_and_b32 v128, 0xffff0000, v126
  v_mul_f32 v127, 1035273459, v127
  v_mul_f32 v128, 1035273459, v128
  v_cvt_pk_bf16_f32 v56, v127, v128
  s_waitcnt vmcnt(8)
  buffer_load_dwordx4 a[52:55], v4, s[32:35], s80 offen offset:2048 nt
  v_mfma_f32_16x16x32_bf16 v[64:67], a[32:35], v[24:27], 0
  s_waitcnt vmcnt(6)
  buffer_load_dwordx4 a[56:59], v4, s[32:35], s80 offen offset:128 nt
  v_mfma_f32_16x16x32_bf16 v[68:71], a[36:39], v[24:27], 0
  s_waitcnt vmcnt(6)
  buffer_load_dwordx4 a[60:63], v4, s[32:35], s80 offen offset:2176 nt
  v_mfma_f32_16x16x32_bf16 v[64:67], a[40:43], v[28:31], v[64:67]
  s_waitcnt vmcnt(6)
  s_mov_b32 s80, 458752
  buffer_load_dwordx4 a[64:67], v4, s[32:35], s80 offen offset:0 nt
  v_mfma_f32_16x16x32_bf16 v[68:71], a[44:47], v[28:31], v[68:71]
  s_mov_b32 s81, 114688
  buffer_load_dwordx4 a[232:235], v7, s[44:47], s81 offen offset:0
  buffer_load_dwordx4 a[248:251], v7, s[44:47], s81 offen offset:1024
  v_add_f32_dpp v124, v73, v72 row_ror:8 row_mask:0xf bank_mask:0x3
  v_add_f32_dpp v125, v75, v74 row_ror:8 row_mask:0xf bank_mask:0x3
  s_nop 0
  v_add_f32_dpp v124, v76, v77 row_ror:8 row_mask:0xf bank_mask:0xc
  v_add_f32_dpp v125, v78, v79 row_ror:8 row_mask:0xf bank_mask:0xc
  v_cvt_pk_bf16_f32 v126, v124, v125
  v_max3_f32 v140, v140, v124, v125
  v_lshlrev_b32 v127, 16, v126
  v_and_b32 v128, 0xffff0000, v126
  v_mul_f32 v127, 1035273459, v127
  v_mul_f32 v128, 1035273459, v128
  v_cvt_pk_bf16_f32 v57, v127, v128
  s_waitcnt vmcnt(8)
  buffer_load_dwordx4 a[68:71], v4, s[32:35], s80 offen offset:2048 nt
  v_mfma_f32_16x16x32_bf16 v[72:75], a[48:51], v[24:27], 0
  s_waitcnt vmcnt(6)
  buffer_load_dwordx4 a[72:75], v4, s[32:35], s80 offen offset:128 nt
  v_mfma_f32_16x16x32_bf16 v[76:79], a[52:55], v[24:27], 0
  s_waitcnt vmcnt(6)
  buffer_load_dwordx4 a[76:79], v4, s[32:35], s80 offen offset:2176 nt
  v_mfma_f32_16x16x32_bf16 v[72:75], a[56:59], v[28:31], v[72:75]
  s_waitcnt vmcnt(6)
  s_mov_b32 s80, 475136
  buffer_load_dwordx4 a[80:83], v4, s[32:35], s80 offen offset:0 nt
  v_mfma_f32_16x16x32_bf16 v[76:79], a[60:63], v[28:31], v[76:79]
  s_mov_b32 s81, 122880
  buffer_load_dwordx4 a[236:239], v7, s[44:47], s81 offen offset:0
  buffer_load_dwordx4 a[252:255], v7, s[44:47], s81 offen offset:1024
  v_add_f32_dpp v124, v65, v64 row_ror:8 row_mask:0xf bank_mask:0x3
  v_add_f32_dpp v125, v67, v66 row_ror:8 row_mask:0xf bank_mask:0x3
  s_nop 0
  v_add_f32_dpp v124, v68, v69 row_ror:8 row_mask:0xf bank_mask:0xc
  v_add_f32_dpp v125, v70, v71 row_ror:8 row_mask:0xf bank_mask:0xc
  v_cvt_pk_bf16_f32 v126, v124, v125
  v_max3_f32 v140, v140, v124, v125
  v_lshlrev_b32 v127, 16, v126
  v_and_b32 v128, 0xffff0000, v126
  v_mul_f32 v127, 1035273459, v127
  v_mul_f32 v128, 1035273459, v128
  v_cvt_pk_bf16_f32 v58, v127, v128
  s_waitcnt vmcnt(8)
  buffer_load_dwordx4 a[84:87], v4, s[32:35], s80 offen offset:2048 nt
  v_mfma_f32_16x16x32_bf16 v[64:67], a[64:67], v[24:27], 0
  s_waitcnt vmcnt(6)
  buffer_load_dwordx4 a[88:91], v4, s[32:35], s80 offen offset:128 nt
  v_mfma_f32_16x16x32_bf16 v[68:71], a[68:71], v[24:27], 0
  s_waitcnt vmcnt(6)
  buffer_load_dwordx4 a[92:95], v4, s[32:35], s80 offen offset:2176 nt
  v_mfma_f32_16x16x32_bf16 v[64:67], a[72:75], v[28:31], v[64:67]
  s_waitcnt vmcnt(6)
  s_mov_b32 s80, 491520
  buffer_load_dwordx4 a[96:99], v4, s[32:35], s80 offen offset:0 nt
  v_mfma_f32_16x16x32_bf16 v[68:71], a[76:79], v[28:31], v[68:71]
  v_add_f32_dpp v124, v73, v72 row_ror:8 row_mask:0xf bank_mask:0x3
  v_add_f32_dpp v125, v75, v74 row_ror:8 row_mask:0xf bank_mask:0x3
  s_nop 0
  v_add_f32_dpp v124, v76, v77 row_ror:8 row_mask:0xf bank_mask:0xc
  v_add_f32_dpp v125, v78, v79 row_ror:8 row_mask:0xf bank_mask:0xc
  v_cvt_pk_bf16_f32 v126, v124, v125
  v_max3_f32 v140, v140, v124, v125
  v_lshlrev_b32 v127, 16, v126
  v_and_b32 v128, 0xffff0000, v126
  v_mul_f32 v127, 1035273459, v127
  v_mul_f32 v128, 1035273459, v128
  v_cvt_pk_bf16_f32 v59, v127, v128
  s_waitcnt vmcnt(6)
  buffer_load_dwordx4 a[100:103], v4, s[32:35], s80 offen offset:2048 nt
  v_mfma_f32_16x16x32_bf16 v[72:75], a[80:83], v[24:27], 0
  s_waitcnt vmcnt(4)
  buffer_load_dwordx4 a[104:107], v4, s[32:35], s80 offen offset:128 nt
  v_mfma_f32_16x16x32_bf16 v[76:79], a[84:87], v[24:27], 0
  s_waitcnt vmcnt(4)
  buffer_load_dwordx4 a[108:111], v4, s[32:35], s80 offen offset:2176 nt
  v_mfma_f32_16x16x32_bf16 v[72:75], a[88:91], v[28:31], v[72:75]
  s_waitcnt vmcnt(4)
  s_mov_b32 s80, 507904
  buffer_load_dwordx4 a[112:115], v4, s[32:35], s80 offen offset:0 nt
  v_mfma_f32_16x16x32_bf16 v[76:79], a[92:95], v[28:31], v[76:79]
  v_add_f32_dpp v124, v65, v64 row_ror:8 row_mask:0xf bank_mask:0x3
  v_add_f32_dpp v125, v67, v66 row_ror:8 row_mask:0xf bank_mask:0x3
  s_nop 0
  v_add_f32_dpp v124, v68, v69 row_ror:8 row_mask:0xf bank_mask:0xc
  v_add_f32_dpp v125, v70, v71 row_ror:8 row_mask:0xf bank_mask:0xc
  v_cvt_pk_bf16_f32 v126, v124, v125
  v_max3_f32 v140, v140, v124, v125
  v_lshlrev_b32 v127, 16, v126
  v_and_b32 v128, 0xffff0000, v126
  v_mul_f32 v127, 1035273459, v127
  v_mul_f32 v128, 1035273459, v128
  v_cvt_pk_bf16_f32 v60, v127, v128
  s_waitcnt vmcnt(4)
  buffer_load_dwordx4 a[116:119], v4, s[32:35], s80 offen offset:2048 nt
  v_mfma_f32_16x16x32_bf16 v[64:67], a[96:99], v[24:27], 0
  s_waitcnt vmcnt(4)
  buffer_load_dwordx4 a[120:123], v4, s[32:35], s80 offen offset:128 nt
  v_mfma_f32_16x16x32_bf16 v[68:71], a[100:103], v[24:27], 0
  s_waitcnt vmcnt(4)
  buffer_load_dwordx4 a[124:127], v4, s[32:35], s80 offen offset:2176 nt
  s_mov_b32 s80, 0
  buffer_load_dwordx4 a[0:3], v5, s[36:39], s80 offen offset:0 nt
  s_cmp_ge_u32 s94, 60
  s_cbranch_scc1 L_xr1
  s_waitcnt vmcnt(5)
  s_cmp_ge_u32 s94, 46
  s_cbranch_scc1 L_xr1
  s_waitcnt vmcnt(4)
L_xr1:
  buffer_load_dwordx4 a[4:7], v5, s[36:39], s80 offen offset:2048 nt
  v_mfma_f32_16x16x32_bf16 v[64:67], a[104:107], v[28:31], v[64:67]
  s_waitcnt vmcnt(6)
  s_cmp_ge_u32 s94, 60
  s_cbranch_scc1 L_xr2
  s_waitcnt vmcnt(5)
  s_cmp_ge_u32 s94, 46
  s_cbranch_scc1 L_xr2
  s_waitcnt vmcnt(4)
L_xr2:
  buffer_load_dwordx4 a[8:11], v5, s[36:39], s80 offen offset:256 nt
  v_mfma_f32_16x16x32_bf16 v[68:71], a[108:111], v[28:31], v[68:71]
  v_add_f32_dpp v124, v73, v72 row_ror:8 row_mask:0xf bank_mask:0x3
  v_add_f32_dpp v125, v75, v74 row_ror:8 row_mask:0xf bank_mask:0x3
  s_nop 0
  v_add_f32_dpp v124, v76, v77 row_ror:8 row_mask:0xf bank_mask:0xc
  v_add_f32_dpp v125, v78, v79 row_ror:8 row_mask:0xf bank_mask:0xc
  v_cvt_pk_bf16_f32 v126, v124, v125
  v_max3_f32 v140, v140, v124, v125
  v_lshlrev_b32 v127, 16, v126
  v_and_b32 v128, 0xffff0000, v126
  v_mul_f32 v127, 1035273459, v127
  v_mul_f32 v128, 1035273459, v128
  v_cvt_pk_bf16_f32 v61, v127, v128
  s_waitcnt vmcnt(6)
  s_cmp_ge_u32 s94, 60
  s_cbranch_scc1 L_xr3
  s_waitcnt vmcnt(5)
  s_cmp_ge_u32 s94, 46
  s_cbranch_scc1 L_xr3
  s_waitcnt vmcnt(4)
L_xr3:
  buffer_load_dwordx4 a[12:15], v5, s[36:39], s80 offen offset:2304 nt
  v_mfma_f32_16x16x32_bf16 v[72:75], a[112:115], v[24:27], 0
  s_waitcnt vmcnt(6)
  s_cmp_ge_u32 s94, 60
  s_cbranch_scc1 L_xr4
  s_waitcnt vmcnt(5)
  s_cmp_ge_u32 s94, 46
  s_cbranch_scc1 L_xr4
  s_waitcnt vmcnt(4)
L_xr4:
  s_mov_b32 s80, 16384
  buffer_load_dwordx4 a[16:19], v5, s[36:39], s80 offen offset:0 nt
  v_mfma_f32_16x16x32_bf16 v[76:79], a[116:119], v[24:27], 0
  s_waitcnt vmcnt(6)
  s_cmp_ge_u32 s94, 60
  s_cbranch_scc1 L_xr5
  s_waitcnt vmcnt(5)
  s_cmp_ge_u32 s94, 46
  s_cbranch_scc1 L_xr5
  s_waitcnt vmcnt(4)
L_xr5:
  buffer_load_dwordx4 a[20:23], v5, s[36:39], s80 offen offset:2048 nt
  v_mfma_f32_16x16x32_bf16 v[72:75], a[120:123], v[28:31], v[72:75]
  s_waitcnt vmcnt(6)
  buffer_atomic_add v247, v238, s[52:55], 0 offen sc0
  buffer_load_dwordx4 a[24:27], v5, s[36:39], s80 offen offset:256 nt
  buffer_load_dwordx4 a[28:31], v5, s[36:39], s80 offen offset:2304 nt
  s_mov_b32 s80, 32768
  buffer_load_dwordx4 a[32:35], v5, s[36:39], s80 offen offset:0 nt
  buffer_load_dwordx4 a[36:39], v5, s[36:39], s80 offen offset:2048 nt
  buffer_load_dwordx4 a[40:43], v5, s[36:39], s80 offen offset:256 nt
  buffer_load_dwordx4 a[44:47], v5, s[36:39], s80 offen offset:2304 nt
  s_mov_b32 s80, 49152
  buffer_load_dwordx4 a[48:51], v5, s[36:39], s80 offen offset:0 nt
  buffer_load_dwordx4 a[52:55], v5, s[36:39], s80 offen offset:2048 nt
  buffer_load_dwordx4 a[56:59], v5, s[36:39], s80 offen offset:256 nt
  buffer_load_dwordx4 a[60:63], v5, s[36:39], s80 offen offset:2304 nt
  v_mfma_f32_16x16x32_bf16 v[76:79], a[124:127], v[28:31], v[76:79]
  v_add_f32_dpp v124, v65, v64 row_ror:8 row_mask:0xf bank_mask:0x3
  v_add_f32_dpp v125, v67, v66 row_ror:8 row_mask:0xf bank_mask:0x3
  s_nop 0
  v_add_f32_dpp v124, v68, v69 row_ror:8 row_mask:0xf bank_mask:0xc
  v_add_f32_dpp v125, v70, v71 row_ror:8 row_mask:0xf bank_mask:0xc
  v_cvt_pk_bf16_f32 v126, v124, v125
  v_max3_f32 v140, v140, v124, v125
  v_lshlrev_b32 v127, 16, v126
  v_and_b32 v128, 0xffff0000, v126
  v_mul_f32 v127, 1035273459, v127
  v_mul_f32 v128, 1035273459, v128
  v_cvt_pk_bf16_f32 v62, v127, v128
  v_add_f32_dpp v124, v73, v72 row_ror:8 row_mask:0xf bank_mask:0x3
  v_add_f32_dpp v125, v75, v74 row_ror:8 row_mask:0xf bank_mask:0x3
  s_nop 0
  v_add_f32_dpp v124, v76, v77 row_ror:8 row_mask:0xf bank_mask:0xc
  v_add_f32_dpp v125, v78, v79 row_ror:8 row_mask:0xf bank_mask:0xc
  v_cvt_pk_bf16_f32 v126, v124, v125
  v_max3_f32 v140, v140, v124, v125
  v_lshlrev_b32 v127, 16, v126
  v_and_b32 v128, 0xffff0000, v126
  v_mul_f32 v127, 1035273459, v127
  v_mul_f32 v128, 1035273459, v128
  v_cvt_pk_bf16_f32 v63, v127, v128
  v_max_f32_dpp v140, v140, v140 row_ror:1 row_mask:0xf bank_mask:0xf
  s_nop 1
  v_max_f32_dpp v140, v140, v140 row_ror:2 row_mask:0xf bank_mask:0xf
  s_nop 1
  v_max_f32_dpp v140, v140, v140 row_ror:4 row_mask:0xf bank_mask:0xf
  s_nop 1
  v_max_f32_dpp v140, v140, v140 row_ror:8 row_mask:0xf bank_mask:0xf
  v_mov_b32 v124, v140
  s_nop 1
  v_permlane16_swap_b32 v140, v124
  v_max_f32 v140, v140, v124
  v_mov_b32 v124, v140
  s_nop 1
  v_permlane32_swap_b32 v140, v124
  v_max_f32 v140, v140, v124
  v_cvt_pk_bf16_f32 v142, 0, v140
  v_mul_f32 v142, 1035273459, v142
  v_cvt_pk_bf16_f32 v142, 0, v142
  v_mul_f32 v143, 1069066811, v142
  v_sub_f32 v143, 0, v143
  s_mov_b32 s88, 1069066811
  v_mov_b32 v141, 0
  v_lshlrev_b32 v124, 16, v32
  v_and_b32 v125, 0xffff0000, v32
  v_fma_f32 v124, v124, s88, v143
  v_fma_f32 v125, v125, s88, v143
  v_exp_f32 v124, v124
  v_exp_f32 v125, v125
  v_add_f32 v141, v141, v124
  v_cvt_pk_bf16_f32 v32, v124, v125
  v_add_f32 v141, v141, v125
  v_lshlrev_b32 v126, 16, v33
  v_and_b32 v127, 0xffff0000, v33
  v_fma_f32 v126, v126, s88, v143
  v_fma_f32 v127, v127, s88, v143
  v_exp_f32 v126, v126
  v_exp_f32 v127, v127
  v_add_f32 v141, v141, v126
  v_cvt_pk_bf16_f32 v33, v126, v127
  v_add_f32 v141, v141, v127
  v_lshlrev_b32 v124, 16, v34
  v_and_b32 v125, 0xffff0000, v34
  v_fma_f32 v124, v124, s88, v143
  v_fma_f32 v125, v125, s88, v143
  v_exp_f32 v124, v124
  v_exp_f32 v125, v125
  v_add_f32 v141, v141, v124
  v_cvt_pk_bf16_f32 v34, v124, v125
  v_add_f32 v141, v141, v125
  v_lshlrev_b32 v126, 16, v35
  v_and_b32 v127, 0xffff0000, v35
  v_fma_f32 v126, v126, s88, v143
  v_fma_f32 v127, v127, s88, v143
  v_exp_f32 v126, v126
  v_exp_f32 v127, v127
  v_add_f32 v141, v141, v126
  v_cvt_pk_bf16_f32 v35, v126, v127
  v_add_f32 v141, v141, v127
  v_lshlrev_b32 v124, 16, v36
  v_and_b32 v125, 0xffff0000, v36
  v_fma_f32 v124, v124, s88, v143
  v_fma_f32 v125, v125, s88, v143
  v_exp_f32 v124, v124
  v_exp_f32 v125, v125
  v_add_f32 v141, v141, v124
  v_cvt_pk_bf16_f32 v36, v124, v125
  v_add_f32 v141, v141, v125
  v_lshlrev_b32 v126, 16, v37
  v_and_b32 v127, 0xffff0000, v37
  v_fma_f32 v126, v126, s88, v143
  v_fma_f32 v127, v127, s88, v143
  v_exp_f32 v126, v126
  v_exp_f32 v127, v127
  v_add_f32 v141, v141, v126
  v_cvt_pk_bf16_f32 v37, v126, v127
  v_add_f32 v141, v141, v127
  v_lshlrev_b32 v124, 16, v38
  v_and_b32 v125, 0xffff0000, v38
  v_fma_f32 v124, v124, s88, v143
  v_fma_f32 v125, v125, s88, v143
  v_exp_f32 v124, v124
  v_exp_f32 v125, v125
  v_add_f32 v141, v141, v124
  v_cvt_pk_bf16_f32 v38, v124, v125
  v_add_f32 v141, v141, v125
  v_lshlrev_b32 v126, 16, v39
  v_and_b32 v127, 0xffff0000, v39
  v_fma_f32 v126, v126, s88, v143
  v_fma_f32 v127, v127, s88, v143
  v_exp_f32 v126, v126
  v_exp_f32 v127, v127
  v_add_f32 v141, v141, v126
  v_cvt_pk_bf16_f32 v39, v126, v127
  v_add_f32 v141, v141, v127
  v_lshlrev_b32 v124, 16, v40
  v_and_b32 v125, 0xffff0000, v40
  v_fma_f32 v124, v124, s88, v143
  v_fma_f32 v125, v125, s88, v143
  v_exp_f32 v124, v124
  v_exp_f32 v125, v125
  v_add_f32 v141, v141, v124
  v_cvt_pk_bf16_f32 v40, v124, v125
  v_add_f32 v141, v141, v125
  v_lshlrev_b32 v126, 16, v41
  v_and_b32 v127, 0xffff0000, v41
  v_fma_f32 v126, v126, s88, v143
  v_fma_f32 v127, v127, s88, v143
  v_exp_f32 v126, v126
  v_exp_f32 v127, v127
  v_add_f32 v141, v141, v126
  v_cvt_pk_bf16_f32 v41, v126, v127
  v_add_f32 v141, v141, v127
  v_lshlrev_b32 v124, 16, v42
  v_and_b32 v125, 0xffff0000, v42
  v_fma_f32 v124, v124, s88, v143
  v_fma_f32 v125, v125, s88, v143
  v_exp_f32 v124, v124
  v_exp_f32 v125, v125
  v_add_f32 v141, v141, v124
  v_cvt_pk_bf16_f32 v42, v124, v125
  v_add_f32 v141, v141, v125
  v_lshlrev_b32 v126, 16, v43
  v_and_b32 v127, 0xffff0000, v43
  v_fma_f32 v126, v126, s88, v143
  v_fma_f32 v127, v127, s88, v143
  v_exp_f32 v126, v126
  v_exp_f32 v127, v127
  v_add_f32 v141, v141, v126
  v_cvt_pk_bf16_f32 v43, v126, v127
  v_add_f32 v141, v141, v127
  v_lshlrev_b32 v124, 16, v44
  v_and_b32 v125, 0xffff0000, v44
  v_fma_f32 v124, v124, s88, v143
  v_fma_f32 v125, v125, s88, v143
  v_exp_f32 v124, v124
  v_exp_f32 v125, v125
  v_add_f32 v141, v141, v124
  v_cvt_pk_bf16_f32 v44, v124, v125
  v_add_f32 v141, v141, v125
  v_lshlrev_b32 v126, 16, v45
  v_and_b32 v127, 0xffff0000, v45
  v_fma_f32 v126, v126, s88, v143
  v_fma_f32 v127, v127, s88, v143
  v_exp_f32 v126, v126
  v_exp_f32 v127, v127
  v_add_f32 v141, v141, v126
  v_cvt_pk_bf16_f32 v45, v126, v127
  v_add_f32 v141, v141, v127
  v_lshlrev_b32 v124, 16, v46
  v_and_b32 v125, 0xffff0000, v46
  v_fma_f32 v124, v124, s88, v143
  v_fma_f32 v125, v125, s88, v143
  v_exp_f32 v124, v124
  v_exp_f32 v125, v125
  v_add_f32 v141, v141, v124
  v_cvt_pk_bf16_f32 v46, v124, v125
  v_add_f32 v141, v141, v125
  v_lshlrev_b32 v126, 16, v47
  v_and_b32 v127, 0xffff0000, v47
  v_fma_f32 v126, v126, s88, v143
  v_fma_f32 v127, v127, s88, v143
  v_exp_f32 v126, v126
  v_exp_f32 v127, v127
  v_add_f32 v141, v141, v126
  v_cvt_pk_bf16_f32 v47, v126, v127
  v_add_f32 v141, v141, v127
  v_lshlrev_b32 v124, 16, v48
  v_and_b32 v125, 0xffff0000, v48
  v_fma_f32 v124, v124, s88, v143
  v_fma_f32 v125, v125, s88, v143
  v_exp_f32 v124, v124
  v_exp_f32 v125, v125
  v_add_f32 v141, v141, v124
  v_cvt_pk_bf16_f32 v48, v124, v125
  v_add_f32 v141, v141, v125
  v_lshlrev_b32 v126, 16, v49
  v_and_b32 v127, 0xffff0000, v49
  v_fma_f32 v126, v126, s88, v143
  v_fma_f32 v127, v127, s88, v143
  v_exp_f32 v126, v126
  v_exp_f32 v127, v127
  v_add_f32 v141, v141, v126
  v_cvt_pk_bf16_f32 v49, v126, v127
  v_add_f32 v141, v141, v127
  v_lshlrev_b32 v124, 16, v50
  v_and_b32 v125, 0xffff0000, v50
  v_fma_f32 v124, v124, s88, v143
  v_fma_f32 v125, v125, s88, v143
  v_exp_f32 v124, v124
  v_exp_f32 v125, v125
  v_add_f32 v141, v141, v124
  v_cvt_pk_bf16_f32 v50, v124, v125
  v_add_f32 v141, v141, v125
  v_lshlrev_b32 v126, 16, v51
  v_and_b32 v127, 0xffff0000, v51
  v_fma_f32 v126, v126, s88, v143
  v_fma_f32 v127, v127, s88, v143
  v_exp_f32 v126, v126
  v_exp_f32 v127, v127
  v_add_f32 v141, v141, v126
  v_cvt_pk_bf16_f32 v51, v126, v127
  v_add_f32 v141, v141, v127
  v_lshlrev_b32 v124, 16, v52
  v_and_b32 v125, 0xffff0000, v52
  v_fma_f32 v124, v124, s88, v143
  v_fma_f32 v125, v125, s88, v143
  v_exp_f32 v124, v124
  v_exp_f32 v125, v125
  v_add_f32 v141, v141, v124
  v_cvt_pk_bf16_f32 v52, v124, v125
  v_add_f32 v141, v141, v125
  v_lshlrev_b32 v126, 16, v53
  v_and_b32 v127, 0xffff0000, v53
  v_fma_f32 v126, v126, s88, v143
  v_fma_f32 v127, v127, s88, v143
  v_exp_f32 v126, v126
  v_exp_f32 v127, v127
  v_add_f32 v141, v141, v126
  v_cvt_pk_bf16_f32 v53, v126, v127
  v_add_f32 v141, v141, v127
  v_lshlrev_b32 v124, 16, v54
  v_and_b32 v125, 0xffff0000, v54
  v_fma_f32 v124, v124, s88, v143
  v_fma_f32 v125, v125, s88, v143
  v_exp_f32 v124, v124
  v_exp_f32 v125, v125
  v_add_f32 v141, v141, v124
  v_cvt_pk_bf16_f32 v54, v124, v125
  v_add_f32 v141, v141, v125
  v_lshlrev_b32 v126, 16, v55
  v_and_b32 v127, 0xffff0000, v55
  v_fma_f32 v126, v126, s88, v143
  v_fma_f32 v127, v127, s88, v143
  v_exp_f32 v126, v126
  v_exp_f32 v127, v127
  v_add_f32 v141, v141, v126
  v_cvt_pk_bf16_f32 v55, v126, v127
  v_add_f32 v141, v141, v127
  v_lshlrev_b32 v124, 16, v56
  v_and_b32 v125, 0xffff0000, v56
  v_fma_f32 v124, v124, s88, v143
  v_fma_f32 v125, v125, s88, v143
  v_exp_f32 v124, v124
  v_exp_f32 v125, v125
  v_add_f32 v141, v141, v124
  v_cvt_pk_bf16_f32 v56, v124, v125
  v_add_f32 v141, v141, v125
  v_lshlrev_b32 v126, 16, v57
  v_and_b32 v127, 0xffff0000, v57
  v_fma_f32 v126, v126, s88, v143
  v_fma_f32 v127, v127, s88, v143
  v_exp_f32 v126, v126
  v_exp_f32 v127, v127
  v_add_f32 v141, v141, v126
  v_cvt_pk_bf16_f32 v57, v126, v127
  v_add_f32 v141, v141, v127
  v_lshlrev_b32 v124, 16, v58
  v_and_b32 v125, 0xffff0000, v58
  v_fma_f32 v124, v124, s88, v143
  v_fma_f32 v125, v125, s88, v143
  v_exp_f32 v124, v124
  v_exp_f32 v125, v125
  v_add_f32 v141, v141, v124
  v_cvt_pk_bf16_f32 v58, v124, v125
  v_add_f32 v141, v141, v125
  v_lshlrev_b32 v126, 16, v59
  v_and_b32 v127, 0xffff0000, v59
  v_fma_f32 v126, v126, s88, v143
  v_fma_f32 v127, v127, s88, v143
  v_exp_f32 v126, v126
  v_exp_f32 v127, v127
  v_add_f32 v141, v141, v126
  v_cvt_pk_bf16_f32 v59, v126, v127
  v_add_f32 v141, v141, v127
  v_lshlrev_b32 v124, 16, v60
  v_and_b32 v125, 0xffff0000, v60
  v_fma_f32 v124, v124, s88, v143
  v_fma_f32 v125, v125, s88, v143
  v_exp_f32 v124, v124
  v_exp_f32 v125, v125
  v_add_f32 v141, v141, v124
  v_cvt_pk_bf16_f32 v60, v124, v125
  v_add_f32 v141, v141, v125
  v_lshlrev_b32 v126, 16, v61
  v_and_b32 v127, 0xffff0000, v61
  v_fma_f32 v126, v126, s88, v143
  v_fma_f32 v127, v127, s88, v143
  v_exp_f32 v126, v126
  v_exp_f32 v127, v127
  v_add_f32 v141, v141, v126
  v_cvt_pk_bf16_f32 v61, v126, v127
  v_add_f32 v141, v141, v127
  v_lshlrev_b32 v124, 16, v62
  v_and_b32 v125, 0xffff0000, v62
  v_fma_f32 v124, v124, s88, v143
  v_fma_f32 v125, v125, s88, v143
  v_exp_f32 v124, v124
  v_exp_f32 v125, v125
  v_add_f32 v141, v141, v124
  v_cvt_pk_bf16_f32 v62, v124, v125
  v_add_f32 v141, v141, v125
  v_lshlrev_b32 v126, 16, v63
  v_and_b32 v127, 0xffff0000, v63
  v_fma_f32 v126, v126, s88, v143
  v_fma_f32 v127, v127, s88, v143
  v_exp_f32 v126, v126
  v_exp_f32 v127, v127
  v_add_f32 v141, v141, v126
  v_cvt_pk_bf16_f32 v63, v126, v127
  v_add_f32 v141, v141, v127
  s_nop 1
  v_add_f32_dpp v141, v141, v141 row_ror:1 row_mask:0xf bank_mask:0xf
  s_nop 1
  v_add_f32_dpp v141, v141, v141 row_ror:2 row_mask:0xf bank_mask:0xf
  s_nop 1
  v_add_f32_dpp v141, v141, v141 row_ror:4 row_mask:0xf bank_mask:0xf
  s_nop 1
  v_add_f32_dpp v141, v141, v141 row_ror:8 row_mask:0xf bank_mask:0xf
  v_mov_b32 v124, v141
  s_nop 1
  v_permlane16_swap_b32 v141, v124
  v_add_f32 v141, v141, v124
  v_mov_b32 v124, v141
  s_nop 1
  v_permlane32_swap_b32 v141, v124
  v_add_f32 v141, v141, v124
  v_mul_f32 v141, 0x3e000000, v141
  v_mov_b32 v124, v142
  v_mov_b32 v125, v141
  buffer_store_dwordx2 v[124:125], v9, s[48:51], 0 offen sc1
  v_perm_b32 v88, v32, v32, v12
  v_perm_b32 v89, v32, v32, v13
  v_perm_b32 v90, v32, v32, v14
  v_perm_b32 v91, v32, v32, v15
  v_perm_b32 v92, v32, v32, v16
  v_perm_b32 v93, v32, v32, v17
  v_perm_b32 v94, v32, v32, v18
  v_perm_b32 v95, v32, v32, v19
  s_waitcnt vmcnt(17)
  v_mfma_f32_16x16x32_bf16 v[80:83], a[0:3], v[88:91], v[80:83]
  s_waitcnt vmcnt(16)
  v_mfma_f32_16x16x32_bf16 v[84:87], a[4:7], v[88:91], v[84:87]
  s_waitcnt vmcnt(15)
  v_mfma_f32_16x16x32_bf16 v[80:83], a[8:11], v[92:95], v[80:83]
  s_waitcnt vmcnt(14)
  v_mfma_f32_16x16x32_bf16 v[84:87], a[12:15], v[92:95], v[84:87]
  s_waitcnt vmcnt(11)
  v_readfirstlane_b32 s95, v247
  s_cmp_eq_u32 s86, 1
  s_cselect_b32 vcc_lo, 12, 0
  s_add_u32 s95, s95, vcc_lo
  s_nop 0
  v_mov_b32 v247, s95
  ds_write_b32 v248, v247
  ds_read_b32 v253, v249
  s_mov_b32 s81, 0
  buffer_load_ushort v176, v232, s[60:63], s81 offen offset:0
  buffer_load_ushort v180, v232, s[60:63], s81 offen offset:3584
  v_accvgpr_read_b32 v124, a128
  v_accvgpr_read_b32 v125, a132
  v_perm_b32 v126, v125, v124, s92
  v_perm_b32 v127, v125, v124, s100
  v_accvgpr_write_b32 a128, v126
  v_accvgpr_write_b32 a132, v127
  v_accvgpr_read_b32 v124, a129
  v_accvgpr_read_b32 v125, a133
  v_accvgpr_read_b32 v128, a136
  v_accvgpr_read_b32 v129, a140
  v_perm_b32 v126, v125, v124, s92
  v_perm_b32 v127, v125, v124, s100
  v_perm_b32 v130, v129, v128, s92
  v_perm_b32 v131, v129, v128, s100
  v_accvgpr_write_b32 a136, v126
  v_accvgpr_write_b32 a140, v127
  v_accvgpr_write_b32 a129, v130
  v_accvgpr_write_b32 a133, v131
  v_perm_b32 v96, v33, v33, v12
  v_perm_b32 v97, v33, v33, v13
  v_perm_b32 v98, v33, v33, v14
  v_perm_b32 v99, v33, v33, v15
  v_perm_b32 v100, v33, v33, v16
  v_perm_b32 v101, v33, v33, v17
  v_perm_b32 v102, v33, v33, v18
  v_perm_b32 v103, v33, v33, v19
  v_mfma_f32_16x16x32_bf16 v[80:83], a[16:19], v[96:99], v[80:83]
  v_mfma_f32_16x16x32_bf16 v[84:87], a[20:23], v[96:99], v[84:87]
  s_waitcnt vmcnt(12)
  v_mfma_f32_16x16x32_bf16 v[80:83], a[24:27], v[100:103], v[80:83]
  s_waitcnt vmcnt(11)
  v_mfma_f32_16x16x32_bf16 v[84:87], a[28:31], v[100:103], v[84:87]
  s_waitcnt lgkmcnt(0)
  v_readfirstlane_b32 s94, v253
  ds_read_b32 v253, v249
  s_mov_b32 s81, 28672
  buffer_load_ushort v177, v232, s[60:63], s81 offen offset:0
  buffer_load_ushort v181, v232, s[60:63], s81 offen offset:3584
  v_accvgpr_read_b32 v124, a130
  v_accvgpr_read_b32 v125, a134
  v_accvgpr_read_b32 v128, a144
  v_accvgpr_read_b32 v129, a148
  v_perm_b32 v126, v125, v124, s92
  v_perm_b32 v127, v125, v124, s100
  v_perm_b32 v130, v129, v128, s92
  v_perm_b32 v131, v129, v128, s100
  v_accvgpr_write_b32 a144, v126
  v_accvgpr_write_b32 a148, v127
  v_accvgpr_write_b32 a130, v130
  v_accvgpr_write_b32 a134, v131
  v_accvgpr_read_b32 v124, a131
  v_accvgpr_read_b32 v125, a135
  v_accvgpr_read_b32 v128, a152
  v_accvgpr_read_b32 v129, a156
  v_perm_b32 v126, v125, v124, s92
  v_perm_b32 v127, v125, v124, s100
  v_perm_b32 v130, v129, v128, s92
  v_perm_b32 v131, v129, v128, s100
  v_accvgpr_write_b32 a152, v126
  v_accvgpr_write_b32 a156, v127
  v_accvgpr_write_b32 a131, v130
  v_accvgpr_write_b32 a135, v131
  v_perm_b32 v88, v34, v34, v12
  v_perm_b32 v89, v34, v34, v13
  v_perm_b32 v90, v34, v34, v14
  v_perm_b32 v91, v34, v34, v15
  v_perm_b32 v92, v34, v34, v16
  v_perm_b32 v93, v34, v34, v17
  v_perm_b32 v94, v34, v34, v18
  v_perm_b32 v95, v34, v34, v19
  s_waitcnt vmcnt(12)
  v_mfma_f32_16x16x32_bf16 v[80:83], a[32:35], v[88:91], v[80:83]
  s_waitcnt vmcnt(11)
  s_cmp_ge_u32 s94, 60
  s_cbranch_scc1 L_xr6
  s_waitcnt vmcnt(10)
  s_cmp_ge_u32 s94, 46
  s_cbranch_scc1 L_xr6
  s_waitcnt vmcnt(9)
L_xr6:
  s_mov_b32 s80, 65536
  buffer_load_dwordx4 a[64:67], v5, s[36:39], s80 offen offset:0 nt
  v_mfma_f32_16x16x32_bf16 v[84:87], a[36:39], v[88:91], v[84:87]
  s_waitcnt vmcnt(11)
  s_cmp_ge_u32 s94, 60
  s_cbranch_scc1 L_xr7
  s_waitcnt vmcnt(10)
  s_cmp_ge_u32 s94, 46
  s_cbranch_scc1 L_xr7
  s_waitcnt vmcnt(9)
L_xr7:
  buffer_load_dwordx4 a[68:71], v5, s[36:39], s80 offen offset:2048 nt
  v_mfma_f32_16x16x32_bf16 v[80:83], a[40:43], v[92:95], v[80:83]
  s_waitcnt vmcnt(11)
  s_cmp_ge_u32 s94, 60
  s_cbranch_scc1 L_xr8
  s_waitcnt vmcnt(10)
  s_cmp_ge_u32 s94, 46
  s_cbranch_scc1 L_xr8
  s_waitcnt vmcnt(9)
L_xr8:
  buffer_load_dwordx4 a[72:75], v5, s[36:39], s80 offen offset:256 nt
  v_mfma_f32_16x16x32_bf16 v[84:87], a[44:47], v[92:95], v[84:87]
  s_waitcnt lgkmcnt(0)
  v_readfirstlane_b32 s94, v253
  ds_read_b32 v253, v249
  s_mov_b32 s81, 57344
  buffer_load_ushort v178, v232, s[60:63], s81 offen offset:0
  buffer_load_ushort v182, v232, s[60:63], s81 offen offset:3584
  v_accvgpr_read_b32 v124, a137
  v_accvgpr_read_b32 v125, a141
  v_perm_b32 v126, v125, v124, s92
  v_perm_b32 v127, v125, v124, s100
  v_accvgpr_write_b32 a137, v126
  v_accvgpr_write_b32 a141, v127
  v_perm_b32 v96, v35, v35, v12
  v_perm_b32 v97, v35, v35, v13
  v_perm_b32 v98, v35, v35, v14
  v_perm_b32 v99, v35, v35, v15
  v_perm_b32 v100, v35, v35, v16
  v_perm_b32 v101, v35, v35, v17
  v_perm_b32 v102, v35, v35, v18
  v_perm_b32 v103, v35, v35, v19
  s_waitcnt vmcnt(13)
  s_cmp_ge_u32 s94, 60
  s_cbranch_scc1 L_xr9
  s_waitcnt vmcnt(12)
  s_cmp_ge_u32 s94, 46
  s_cbranch_scc1 L_xr9
  s_waitcnt vmcnt(11)
L_xr9:
  buffer_load_dwordx4 a[76:79], v5, s[36:39], s80 offen offset:2304 nt
  v_mfma_f32_16x16x32_bf16 v[80:83], a[48:51], v[96:99], v[80:83]
  s_waitcnt vmcnt(13)
  s_cmp_ge_u32 s94, 60
  s_cbranch_scc1 L_xr10
  s_waitcnt vmcnt(12)
  s_cmp_ge_u32 s94, 46
  s_cbranch_scc1 L_xr10
  s_waitcnt vmcnt(11)
L_xr10:
  s_mov_b32 s80, 81920
  buffer_load_dwordx4 a[80:83], v5, s[36:39], s80 offen offset:0 nt
  v_mfma_f32_16x16x32_bf16 v[84:87], a[52:55], v[96:99], v[84:87]
  s_waitcnt vmcnt(13)
  s_cmp_ge_u32 s94, 60
  s_cbranch_scc1 L_xr11
  s_waitcnt vmcnt(12)
  s_cmp_ge_u32 s94, 46
  s_cbranch_scc1 L_xr11
  s_waitcnt vmcnt(6)
L_xr11:
  buffer_load_dwordx4 a[84:87], v5, s[36:39], s80 offen offset:2048 nt
  v_mfma_f32_16x16x32_bf16 v[80:83], a[56:59], v[100:103], v[80:83]
  s_waitcnt vmcnt(13)
  s_cmp_ge_u32 s94, 60
  s_cbranch_scc1 L_xr12
  s_waitcnt vmcnt(7)
  s_cmp_ge_u32 s94, 46
  s_cbranch_scc1 L_xr12
  s_waitcnt vmcnt(6)
L_xr12:
  buffer_load_dwordx4 a[88:91], v5, s[36:39], s80 offen offset:256 nt
  v_mfma_f32_16x16x32_bf16 v[84:87], a[60:63], v[100:103], v[84:87]
  s_waitcnt lgkmcnt(0)
  v_readfirstlane_b32 s94, v253
  s_mov_b32 s81, 86016
  buffer_load_ushort v179, v232, s[60:63], s81 offen offset:0
  buffer_load_ushort v183, v232, s[60:63], s81 offen offset:3584
  v_accvgpr_read_b32 v124, a138
  v_accvgpr_read_b32 v125, a142
  v_accvgpr_read_b32 v128, a145
  v_accvgpr_read_b32 v129, a149
  v_perm_b32 v126, v125, v124, s92
  v_perm_b32 v127, v125, v124, s100
  v_perm_b32 v130, v129, v128, s92
  v_perm_b32 v131, v129, v128, s100
  v_accvgpr_write_b32 a145, v126
  v_accvgpr_write_b32 a149, v127
  v_accvgpr_write_b32 a138, v130
  v_accvgpr_write_b32 a142, v131
  v_accvgpr_read_b32 v124, a139
  v_accvgpr_read_b32 v125, a143
  v_accvgpr_read_b32 v128, a153
  v_accvgpr_read_b32 v129, a157
  v_perm_b32 v126, v125, v124, s92
  v_perm_b32 v127, v125, v124, s100
  v_perm_b32 v130, v129, v128, s92
  v_perm_b32 v131, v129, v128, s100
  v_accvgpr_write_b32 a153, v126
  v_accvgpr_write_b32 a157, v127
  v_accvgpr_write_b32 a139, v130
  v_accvgpr_write_b32 a143, v131
  v_perm_b32 v88, v36, v36, v12
  v_perm_b32 v89, v36, v36, v13
  v_perm_b32 v90, v36, v36, v14
  v_perm_b32 v91, v36, v36, v15
  v_perm_b32 v92, v36, v36, v16
  v_perm_b32 v93, v36, v36, v17
  v_perm_b32 v94, v36, v36, v18
  v_perm_b32 v95, v36, v36, v19
  s_waitcnt vmcnt(10)
  s_cmp_ge_u32 s94, 60
  s_cbranch_scc1 L_xr13
  s_waitcnt vmcnt(9)
  s_cmp_ge_u32 s94, 46
  s_cbranch_scc1 L_xr13
  s_waitcnt vmcnt(8)
L_xr13:
  buffer_load_dwordx4 a[92:95], v5, s[36:39], s80 offen offset:2304 nt
  v_mfma_f32_16x16x32_bf16 v[80:83], a[64:67], v[88:91], v[80:83]
  s_waitcnt vmcnt(10)
  s_cmp_ge_u32 s94, 60
  s_cbranch_scc1 L_xr14
  s_waitcnt vmcnt(9)
  s_cmp_ge_u32 s94, 46
  s_cbranch_scc1 L_xr14
  s_waitcnt vmcnt(6)
L_xr14:
  s_mov_b32 s80, 98304
  buffer_load_dwordx4 a[96:99], v5, s[36:39], s80 offen offset:0 nt
  v_mfma_f32_16x16x32_bf16 v[84:87], a[68:71], v[88:91], v[84:87]
  s_waitcnt vmcnt(10)
  s_cmp_ge_u32 s94, 60
  s_cbranch_scc1 L_xr15
  s_waitcnt vmcnt(7)
  s_cmp_ge_u32 s94, 46
  s_cbranch_scc1 L_xr15
  s_waitcnt vmcnt(6)
L_xr15:
  buffer_load_dwordx4 a[100:103], v5, s[36:39], s80 offen offset:2048 nt
  v_mfma_f32_16x16x32_bf16 v[80:83], a[72:75], v[92:95], v[80:83]
  s_waitcnt vmcnt(8)
  s_cmp_ge_u32 s94, 60
  s_cbranch_scc1 L_xr16
  s_waitcnt vmcnt(7)
  s_cmp_ge_u32 s94, 46
  s_cbranch_scc1 L_xr16
  s_waitcnt vmcnt(6)
L_xr16:
  buffer_load_dwordx4 a[104:107], v5, s[36:39], s80 offen offset:256 nt
  v_mfma_f32_16x16x32_bf16 v[84:87], a[76:79], v[92:95], v[84:87]
  ds_read_b32 v253, v249
  s_mov_b32 s81, 114688
  buffer_load_ushort v184, v232, s[60:63], s81 offen offset:0
  buffer_load_ushort v188, v232, s[60:63], s81 offen offset:3584
  v_accvgpr_read_b32 v124, a146
  v_accvgpr_read_b32 v125, a150
  v_perm_b32 v126, v125, v124, s92
  v_perm_b32 v127, v125, v124, s100
  v_accvgpr_write_b32 a146, v126
  v_accvgpr_write_b32 a150, v127
  v_accvgpr_read_b32 v124, a147
  v_accvgpr_read_b32 v125, a151
  v_accvgpr_read_b32 v128, a154
  v_accvgpr_read_b32 v129, a158
  v_perm_b32 v126, v125, v124, s92
  v_perm_b32 v127, v125, v124, s100
  v_perm_b32 v130, v129, v128, s92
  v_perm_b32 v131, v129, v128, s100
  v_accvgpr_write_b32 a154, v126
  v_accvgpr_write_b32 a158, v127
  v_accvgpr_write_b32 a147, v130
  v_accvgpr_write_b32 a151, v131
  v_perm_b32 v96, v37, v37, v12
  v_perm_b32 v97, v37, v37, v13
  v_perm_b32 v98, v37, v37, v14
  v_perm_b32 v99, v37, v37, v15
  v_perm_b32 v100, v37, v37, v16
  v_perm_b32 v101, v37, v37, v17
  v_perm_b32 v102, v37, v37, v18
  v_perm_b32 v103, v37, v37, v19
  s_waitcnt vmcnt(10)
  s_cmp_ge_u32 s94, 60
  s_cbranch_scc1 L_xr17
  s_waitcnt vmcnt(9)
  s_cmp_ge_u32 s94, 46
  s_cbranch_scc1 L_xr17
  s_waitcnt vmcnt(8)
L_xr17:
  buffer_load_dwordx4 a[108:111], v5, s[36:39], s80 offen offset:2304 nt
  v_mfma_f32_16x16x32_bf16 v[80:83], a[80:83], v[96:99], v[80:83]
  s_waitcnt vmcnt(10)
  s_cmp_ge_u32 s94, 60
  s_cbranch_scc1 L_xr18
  s_waitcnt vmcnt(9)
  s_cmp_ge_u32 s94, 46
  s_cbranch_scc1 L_xr18
  s_waitcnt vmcnt(6)
L_xr18:
  s_mov_b32 s80, 114688
  buffer_load_dwordx4 a[112:115], v5, s[36:39], s80 offen offset:0 nt
  v_mfma_f32_16x16x32_bf16 v[84:87], a[84:87], v[96:99], v[84:87]
  s_waitcnt vmcnt(10)
  s_cmp_ge_u32 s94, 60
  s_cbranch_scc1 L_xr19
  s_waitcnt vmcnt(7)
  s_cmp_ge_u32 s94, 46
  s_cbranch_scc1 L_xr19
  s_waitcnt vmcnt(6)
L_xr19:
  buffer_load_dwordx4 a[116:119], v5, s[36:39], s80 offen offset:2048 nt
  v_mfma_f32_16x16x32_bf16 v[80:83], a[88:91], v[100:103], v[80:83]
  s_waitcnt vmcnt(8)
  s_cmp_ge_u32 s94, 60
  s_cbranch_scc1 L_xr20
  s_waitcnt vmcnt(7)
  s_cmp_ge_u32 s94, 46
  s_cbranch_scc1 L_xr20
  s_waitcnt vmcnt(6)
L_xr20:
  buffer_load_dwordx4 a[120:123], v5, s[36:39], s80 offen offset:256 nt
  v_mfma_f32_16x16x32_bf16 v[84:87], a[92:95], v[100:103], v[84:87]
  s_waitcnt lgkmcnt(0)
  v_readfirstlane_b32 s94, v253
  s_mov_b32 s81, 143360
  buffer_load_ushort v185, v232, s[60:63], s81 offen offset:0
  buffer_load_ushort v189, v232, s[60:63], s81 offen offset:3584
  v_accvgpr_read_b32 v124, a155
  v_accvgpr_read_b32 v125, a159
  v_perm_b32 v126, v125, v124, s92
  v_perm_b32 v127, v125, v124, s100
  v_accvgpr_write_b32 a155, v126
  v_accvgpr_write_b32 a159, v127
  v_perm_b32 v88, v38, v38, v12
  v_perm_b32 v89, v38, v38, v13
  v_perm_b32 v90, v38, v38, v14
  v_perm_b32 v91, v38, v38, v15
  v_perm_b32 v92, v38, v38, v16
  v_perm_b32 v93, v38, v38, v17
  v_perm_b32 v94, v38, v38, v18
  v_perm_b32 v95, v38, v38, v19
  s_waitcnt vmcnt(10)
  s_cmp_ge_u32 s94, 60
  s_cbranch_scc1 L_xr21
  s_waitcnt vmcnt(9)
  s_cmp_ge_u32 s94, 46
  s_cbranch_scc1 L_xr21
  s_waitcnt vmcnt(8)
L_xr21:
  buffer_load_dwordx4 a[124:127], v5, s[36:39], s80 offen offset:2304 nt
  v_mfma_f32_16x16x32_bf16 v[80:83], a[96:99], v[88:91], v[80:83]
  s_waitcnt vmcnt(10)
  s_cmp_ge_u32 s94, 60
  s_cbranch_scc1 L_xr22
  s_waitcnt vmcnt(9)
  s_cmp_ge_u32 s94, 46
  s_cbranch_scc1 L_xr22
  s_waitcnt vmcnt(6)
L_xr22:
  s_mov_b32 s80, 131072
  buffer_load_dwordx4 a[0:3], v5, s[36:39], s80 offen offset:0 nt
  v_mfma_f32_16x16x32_bf16 v[84:87], a[100:103], v[88:91], v[84:87]
  s_waitcnt vmcnt(10)
  s_cmp_ge_u32 s94, 60
  s_cbranch_scc1 L_xr23
  s_waitcnt vmcnt(7)
  s_cmp_ge_u32 s94, 46
  s_cbranch_scc1 L_xr23
  s_waitcnt vmcnt(6)
L_xr23:
  buffer_load_dwordx4 a[4:7], v5, s[36:39], s80 offen offset:2048 nt
  v_mfma_f32_16x16x32_bf16 v[80:83], a[104:107], v[92:95], v[80:83]
  s_waitcnt vmcnt(8)
  s_cmp_ge_u32 s94, 60
  s_cbranch_scc1 L_xr24
  s_waitcnt vmcnt(7)
  s_cmp_ge_u32 s94, 46
  s_cbranch_scc1 L_xr24
  s_waitcnt vmcnt(6)
L_xr24:
  buffer_load_dwordx4 a[8:11], v5, s[36:39], s80 offen offset:256 nt
  v_mfma_f32_16x16x32_bf16 v[84:87], a[108:111], v[92:95], v[84:87]
  s_mov_b32 s81, 172032
  buffer_load_ushort v186, v232, s[60:63], s81 offen offset:0
  buffer_load_ushort v190, v232, s[60:63], s81 offen offset:3584
  v_accvgpr_read_b32 v124, a160
  v_accvgpr_read_b32 v125, a164
  v_perm_b32 v126, v125, v124, s92
  v_perm_b32 v127, v125, v124, s100
  v_accvgpr_write_b32 a160, v126
  v_accvgpr_write_b32 a164, v127
  v_accvgpr_read_b32 v124, a161
  v_accvgpr_read_b32 v125, a165
  v_accvgpr_read_b32 v128, a168
  v_accvgpr_read_b32 v129, a172
  v_perm_b32 v126, v125, v124, s92
  v_perm_b32 v127, v125, v124, s100
  v_perm_b32 v130, v129, v128, s92
  v_perm_b32 v131, v129, v128, s100
  v_accvgpr_write_b32 a168, v126
  v_accvgpr_write_b32 a172, v127
  v_accvgpr_write_b32 a161, v130
  v_accvgpr_write_b32 a165, v131
  v_perm_b32 v96, v39, v39, v12
  v_perm_b32 v97, v39, v39, v13
  v_perm_b32 v98, v39, v39, v14
  v_perm_b32 v99, v39, v39, v15
  v_perm_b32 v100, v39, v39, v16
  v_perm_b32 v101, v39, v39, v17
  v_perm_b32 v102, v39, v39, v18
  v_perm_b32 v103, v39, v39, v19
  s_waitcnt vmcnt(10)
  s_cmp_ge_u32 s94, 60
  s_cbranch_scc1 L_xr25
  s_waitcnt vmcnt(9)
  s_cmp_ge_u32 s94, 46
  s_cbranch_scc1 L_xr25
  s_waitcnt vmcnt(8)
L_xr25:
  buffer_load_dwordx4 a[12:15], v5, s[36:39], s80 offen offset:2304 nt
  v_mfma_f32_16x16x32_bf16 v[80:83], a[112:115], v[96:99], v[80:83]
  s_waitcnt vmcnt(10)
  s_cmp_ge_u32 s94, 60
  s_cbranch_scc1 L_xr26
  s_waitcnt vmcnt(9)
  s_cmp_ge_u32 s94, 46
  s_cbranch_scc1 L_xr26
  s_waitcnt vmcnt(6)
L_xr26:
  s_mov_b32 s80, 147456
  buffer_load_dwordx4 a[16:19], v5, s[36:39], s80 offen offset:0 nt
  v_mfma_f32_16x16x32_bf16 v[84:87], a[116:119], v[96:99], v[84:87]
  s_waitcnt vmcnt(10)
  s_cmp_ge_u32 s94, 60
  s_cbranch_scc1 L_xr27
  s_waitcnt vmcnt(7)
  s_cmp_ge_u32 s94, 46
  s_cbranch_scc1 L_xr27
  s_waitcnt vmcnt(6)
L_xr27:
  buffer_load_dwordx4 a[20:23], v5, s[36:39], s80 offen offset:2048 nt
  v_mfma_f32_16x16x32_bf16 v[80:83], a[120:123], v[100:103], v[80:83]
  s_waitcnt vmcnt(8)
  s_cmp_ge_u32 s94, 60
  s_cbranch_scc1 L_xr28
  s_waitcnt vmcnt(7)
  s_cmp_ge_u32 s94, 46
  s_cbranch_scc1 L_xr28
  s_waitcnt vmcnt(6)
L_xr28:
  buffer_load_dwordx4 a[24:27], v5, s[36:39], s80 offen offset:256 nt
  v_mfma_f32_16x16x32_bf16 v[84:87], a[124:127], v[100:103], v[84:87]
  s_mov_b32 s81, 200704
  buffer_load_ushort v187, v232, s[60:63], s81 offen offset:0
  buffer_load_ushort v191, v232, s[60:63], s81 offen offset:3584
  v_accvgpr_read_b32 v124, a162
  v_accvgpr_read_b32 v125, a166
  v_accvgpr_read_b32 v128, a176
  v_accvgpr_read_b32 v129, a180
  v_perm_b32 v126, v125, v124, s92
  v_perm_b32 v127, v125, v124, s100
  v_perm_b32 v130, v129, v128, s92
  v_perm_b32 v131, v129, v128, s100
  v_accvgpr_write_b32 a176, v126
  v_accvgpr_write_b32 a180, v127
  v_accvgpr_write_b32 a162, v130
  v_accvgpr_write_b32 a166, v131
  v_accvgpr_read_b32 v124, a163
  v_accvgpr_read_b32 v125, a167
  v_accvgpr_read_b32 v128, a184
  v_accvgpr_read_b32 v129, a188
  v_perm_b32 v126, v125, v124, s92
  v_perm_b32 v127, v125, v124, s100
  v_perm_b32 v130, v129, v128, s92
  v_perm_b32 v131, v129, v128, s100
  v_accvgpr_write_b32 a184, v126
  v_accvgpr_write_b32 a188, v127
  v_accvgpr_write_b32 a163, v130
  v_accvgpr_write_b32 a167, v131
  v_perm_b32 v88, v40, v40, v12
  v_perm_b32 v89, v40, v40, v13
  v_perm_b32 v90, v40, v40, v14
  v_perm_b32 v91, v40, v40, v15
  v_perm_b32 v92, v40, v40, v16
  v_perm_b32 v93, v40, v40, v17
  v_perm_b32 v94, v40, v40, v18
  v_perm_b32 v95, v40, v40, v19
  s_waitcnt vmcnt(10)
  s_cmp_ge_u32 s94, 60
  s_cbranch_scc1 L_xr29
  s_waitcnt vmcnt(9)
  s_cmp_ge_u32 s94, 46
  s_cbranch_scc1 L_xr29
  s_waitcnt vmcnt(8)
L_xr29:
  buffer_load_dwordx4 a[28:31], v5, s[36:39], s80 offen offset:2304 nt
  v_mfma_f32_16x16x32_bf16 v[80:83], a[0:3], v[88:91], v[80:83]
  s_waitcnt vmcnt(10)
  s_cmp_ge_u32 s94, 60
  s_cbranch_scc1 L_xr30
  s_waitcnt vmcnt(9)
  s_cmp_ge_u32 s94, 46
  s_cbranch_scc1 L_xr30
  s_waitcnt vmcnt(6)
L_xr30:
  s_mov_b32 s80, 163840
  buffer_load_dwordx4 a[32:35], v5, s[36:39], s80 offen offset:0 nt
  v_mfma_f32_16x16x32_bf16 v[84:87], a[4:7], v[88:91], v[84:87]
  s_waitcnt vmcnt(10)
  s_cmp_ge_u32 s94, 60
  s_cbranch_scc1 L_xr31
  s_waitcnt vmcnt(7)
  s_cmp_ge_u32 s94, 46
  s_cbranch_scc1 L_xr31
  s_waitcnt vmcnt(6)
L_xr31:
  buffer_load_dwordx4 a[36:39], v5, s[36:39], s80 offen offset:2048 nt
  v_mfma_f32_16x16x32_bf16 v[80:83], a[8:11], v[92:95], v[80:83]
  s_waitcnt vmcnt(8)
  s_cmp_ge_u32 s94, 60
  s_cbranch_scc1 L_xr32
  s_waitcnt vmcnt(7)
  s_cmp_ge_u32 s94, 46
  s_cbranch_scc1 L_xr32
  s_waitcnt vmcnt(6)
L_xr32:
  buffer_load_dwordx4 a[40:43], v5, s[36:39], s80 offen offset:256 nt
  v_mfma_f32_16x16x32_bf16 v[84:87], a[12:15], v[92:95], v[84:87]
  s_mov_b32 s81, 229376
  buffer_load_ushort v192, v232, s[60:63], s81 offen offset:0
  buffer_load_ushort v196, v232, s[60:63], s81 offen offset:3584
  v_accvgpr_read_b32 v124, a169
  v_accvgpr_read_b32 v125, a173
  v_perm_b32 v126, v125, v124, s92
  v_perm_b32 v127, v125, v124, s100
  v_accvgpr_write_b32 a169, v126
  v_accvgpr_write_b32 a173, v127
  v_perm_b32 v96, v41, v41, v12
  v_perm_b32 v97, v41, v41, v13
  v_perm_b32 v98, v41, v41, v14
  v_perm_b32 v99, v41, v41, v15
  v_perm_b32 v100, v41, v41, v16
  v_perm_b32 v101, v41, v41, v17
  v_perm_b32 v102, v41, v41, v18
  v_perm_b32 v103, v41, v41, v19
  s_waitcnt vmcnt(10)
  s_cmp_ge_u32 s94, 60
  s_cbranch_scc1 L_xr33
  s_waitcnt vmcnt(9)
  s_cmp_ge_u32 s94, 46
  s_cbranch_scc1 L_xr33
  s_waitcnt vmcnt(8)
L_xr33:
  buffer_load_dwordx4 a[44:47], v5, s[36:39], s80 offen offset:2304 nt
  v_mfma_f32_16x16x32_bf16 v[80:83], a[16:19], v[96:99], v[80:83]
  s_waitcnt vmcnt(10)
  s_cmp_ge_u32 s94, 60
  s_cbranch_scc1 L_xr34
  s_waitcnt vmcnt(9)
  s_cmp_ge_u32 s94, 46
  s_cbranch_scc1 L_xr34
  s_waitcnt vmcnt(6)
L_xr34:
  s_mov_b32 s80, 180224
  buffer_load_dwordx4 a[48:51], v5, s[36:39], s80 offen offset:0 nt
  v_mfma_f32_16x16x32_bf16 v[84:87], a[20:23], v[96:99], v[84:87]
  s_waitcnt vmcnt(10)
  s_cmp_ge_u32 s94, 60
  s_cbranch_scc1 L_xr35
  s_waitcnt vmcnt(7)
  s_cmp_ge_u32 s94, 46
  s_cbranch_scc1 L_xr35
  s_waitcnt vmcnt(6)
L_xr35:
  buffer_load_dwordx4 a[52:55], v5, s[36:39], s80 offen offset:2048 nt
  v_mfma_f32_16x16x32_bf16 v[80:83], a[24:27], v[100:103], v[80:83]
  s_waitcnt vmcnt(8)
  s_cmp_ge_u32 s94, 60
  s_cbranch_scc1 L_xr36
  s_waitcnt vmcnt(7)
  s_cmp_ge_u32 s94, 46
  s_cbranch_scc1 L_xr36
  s_waitcnt vmcnt(6)
L_xr36:
  buffer_load_dwordx4 a[56:59], v5, s[36:39], s80 offen offset:256 nt
  v_mfma_f32_16x16x32_bf16 v[84:87], a[28:31], v[100:103], v[84:87]
  s_mov_b32 s81, 258048
  buffer_load_ushort v193, v232, s[60:63], s81 offen offset:0
  buffer_load_ushort v197, v232, s[60:63], s81 offen offset:3584
  v_accvgpr_read_b32 v124, a170
  v_accvgpr_read_b32 v125, a174
  v_accvgpr_read_b32 v128, a177
  v_accvgpr_read_b32 v129, a181
  v_perm_b32 v126, v125, v124, s92
  v_perm_b32 v127, v125, v124, s100
  v_perm_b32 v130, v129, v128, s92
  v_perm_b32 v131, v129, v128, s100
  v_accvgpr_write_b32 a177, v126
  v_accvgpr_write_b32 a181, v127
  v_accvgpr_write_b32 a170, v130
  v_accvgpr_write_b32 a174, v131
  v_accvgpr_read_b32 v124, a171
  v_accvgpr_read_b32 v125, a175
  v_accvgpr_read_b32 v128, a185
  v_accvgpr_read_b32 v129, a189
  v_perm_b32 v126, v125, v124, s92
  v_perm_b32 v127, v125, v124, s100
  v_perm_b32 v130, v129, v128, s92
  v_perm_b32 v131, v129, v128, s100
  v_accvgpr_write_b32 a185, v126
  v_accvgpr_write_b32 a189, v127
  v_accvgpr_write_b32 a171, v130
  v_accvgpr_write_b32 a175, v131
  v_perm_b32 v88, v42, v42, v12
  v_perm_b32 v89, v42, v42, v13
  v_perm_b32 v90, v42, v42, v14
  v_perm_b32 v91, v42, v42, v15
  v_perm_b32 v92, v42, v42, v16
  v_perm_b32 v93, v42, v42, v17
  v_perm_b32 v94, v42, v42, v18
  v_perm_b32 v95, v42, v42, v19
  s_waitcnt vmcnt(10)
  s_cmp_ge_u32 s94, 60
  s_cbranch_scc1 L_xr37
  s_waitcnt vmcnt(9)
  s_cmp_ge_u32 s94, 46
  s_cbranch_scc1 L_xr37
  s_waitcnt vmcnt(8)
L_xr37:
  buffer_load_dwordx4 a[60:63], v5, s[36:39], s80 offen offset:2304 nt
  v_mfma_f32_16x16x32_bf16 v[80:83], a[32:35], v[88:91], v[80:83]
  s_waitcnt vmcnt(10)
  s_cmp_ge_u32 s94, 60
  s_cbranch_scc1 L_xr38
  s_waitcnt vmcnt(9)
  s_cmp_ge_u32 s94, 46
  s_cbranch_scc1 L_xr38
  s_waitcnt vmcnt(6)
L_xr38:
  s_mov_b32 s80, 196608
  buffer_load_dwordx4 a[64:67], v5, s[36:39], s80 offen offset:0 nt
  v_mfma_f32_16x16x32_bf16 v[84:87], a[36:39], v[88:91], v[84:87]
  s_waitcnt vmcnt(10)
  s_cmp_ge_u32 s94, 60
  s_cbranch_scc1 L_xr39
  s_waitcnt vmcnt(7)
  s_cmp_ge_u32 s94, 46
  s_cbranch_scc1 L_xr39
  s_waitcnt vmcnt(6)
L_xr39:
  buffer_load_dwordx4 a[68:71], v5, s[36:39], s80 offen offset:2048 nt
  v_mfma_f32_16x16x32_bf16 v[80:83], a[40:43], v[92:95], v[80:83]
  s_waitcnt vmcnt(8)
  s_cmp_ge_u32 s94, 60
  s_cbranch_scc1 L_xr40
  s_waitcnt vmcnt(7)
  s_cmp_ge_u32 s94, 46
  s_cbranch_scc1 L_xr40
  s_waitcnt vmcnt(6)
L_xr40:
  buffer_load_dwordx4 a[72:75], v5, s[36:39], s80 offen offset:256 nt
  v_mfma_f32_16x16x32_bf16 v[84:87], a[44:47], v[92:95], v[84:87]
  s_mov_b32 s81, 286720
  buffer_load_ushort v194, v232, s[60:63], s81 offen offset:0
  buffer_load_ushort v198, v232, s[60:63], s81 offen offset:3584
  v_accvgpr_read_b32 v124, a178
  v_accvgpr_read_b32 v125, a182
  v_perm_b32 v126, v125, v124, s92
  v_perm_b32 v127, v125, v124, s100
  v_accvgpr_write_b32 a178, v126
  v_accvgpr_write_b32 a182, v127
  v_accvgpr_read_b32 v124, a179
  v_accvgpr_read_b32 v125, a183
  v_accvgpr_read_b32 v128, a186
  v_accvgpr_read_b32 v129, a190
  v_perm_b32 v126, v125, v124, s92
  v_perm_b32 v127, v125, v124, s100
  v_perm_b32 v130, v129, v128, s92
  v_perm_b32 v131, v129, v128, s100
  v_accvgpr_write_b32 a186, v126
  v_accvgpr_write_b32 a190, v127
  v_accvgpr_write_b32 a179, v130
  v_accvgpr_write_b32 a183, v131
  v_perm_b32 v96, v43, v43, v12
  v_perm_b32 v97, v43, v43, v13
  v_perm_b32 v98, v43, v43, v14
  v_perm_b32 v99, v43, v43, v15
  v_perm_b32 v100, v43, v43, v16
  v_perm_b32 v101, v43, v43, v17
  v_perm_b32 v102, v43, v43, v18
  v_perm_b32 v103, v43, v43, v19
  s_waitcnt vmcnt(10)
  s_cmp_ge_u32 s94, 60
  s_cbranch_scc1 L_xr41
  s_waitcnt vmcnt(9)
  s_cmp_ge_u32 s94, 46
  s_cbranch_scc1 L_xr41
  s_waitcnt vmcnt(8)
L_xr41:
  buffer_load_dwordx4 a[76:79], v5, s[36:39], s80 offen offset:2304 nt
  v_mfma_f32_16x16x32_bf16 v[80:83], a[48:51], v[96:99], v[80:83]
  s_waitcnt vmcnt(10)
  s_cmp_ge_u32 s94, 60
  s_cbranch_scc1 L_xr42
  s_waitcnt vmcnt(9)
  s_cmp_ge_u32 s94, 46
  s_cbranch_scc1 L_xr42
  s_waitcnt vmcnt(6)
L_xr42:
  s_mov_b32 s80, 212992
  buffer_load_dwordx4 a[80:83], v5, s[36:39], s80 offen offset:0 nt
  v_mfma_f32_16x16x32_bf16 v[84:87], a[52:55], v[96:99], v[84:87]
  s_waitcnt vmcnt(10)
  s_cmp_ge_u32 s94, 60
  s_cbranch_scc1 L_xr43
  s_waitcnt vmcnt(7)
  s_cmp_ge_u32 s94, 46
  s_cbranch_scc1 L_xr43
  s_waitcnt vmcnt(6)
L_xr43:
  buffer_load_dwordx4 a[84:87], v5, s[36:39], s80 offen offset:2048 nt
  v_mfma_f32_16x16x32_bf16 v[80:83], a[56:59], v[100:103], v[80:83]
  s_waitcnt vmcnt(8)
  s_cmp_ge_u32 s94, 60
  s_cbranch_scc1 L_xr44
  s_waitcnt vmcnt(7)
  s_cmp_ge_u32 s94, 46
  s_cbranch_scc1 L_xr44
  s_waitcnt vmcnt(6)
L_xr44:
  buffer_load_dwordx4 a[88:91], v5, s[36:39], s80 offen offset:256 nt
  v_mfma_f32_16x16x32_bf16 v[84:87], a[60:63], v[100:103], v[84:87]
  s_mov_b32 s81, 315392
  buffer_load_ushort v195, v232, s[60:63], s81 offen offset:0
  buffer_load_ushort v199, v232, s[60:63], s81 offen offset:3584
  v_accvgpr_read_b32 v124, a187
  v_accvgpr_read_b32 v125, a191
  v_perm_b32 v126, v125, v124, s92
  v_perm_b32 v127, v125, v124, s100
  v_accvgpr_write_b32 a187, v126
  v_accvgpr_write_b32 a191, v127
  v_perm_b32 v88, v44, v44, v12
  v_perm_b32 v89, v44, v44, v13
  v_perm_b32 v90, v44, v44, v14
  v_perm_b32 v91, v44, v44, v15
  v_perm_b32 v92, v44, v44, v16
  v_perm_b32 v93, v44, v44, v17
  v_perm_b32 v94, v44, v44, v18
  v_perm_b32 v95, v44, v44, v19
  s_waitcnt vmcnt(10)
  s_cmp_ge_u32 s94, 60
  s_cbranch_scc1 L_xr45
  s_waitcnt vmcnt(9)
  s_cmp_ge_u32 s94, 46
  s_cbranch_scc1 L_xr45
  s_waitcnt vmcnt(8)
L_xr45:
  buffer_load_dwordx4 a[92:95], v5, s[36:39], s80 offen offset:2304 nt
  v_mfma_f32_16x16x32_bf16 v[80:83], a[64:67], v[88:91], v[80:83]
  s_waitcnt vmcnt(10)
  s_cmp_ge_u32 s94, 60
  s_cbranch_scc1 L_xr46
  s_waitcnt vmcnt(9)
  s_cmp_ge_u32 s94, 46
  s_cbranch_scc1 L_xr46
  s_waitcnt vmcnt(6)
L_xr46:
  s_mov_b32 s80, 229376
  buffer_load_dwordx4 a[96:99], v5, s[36:39], s80 offen offset:0 nt
  v_mfma_f32_16x16x32_bf16 v[84:87], a[68:71], v[88:91], v[84:87]
  s_waitcnt vmcnt(10)
  s_cmp_ge_u32 s94, 60
  s_cbranch_scc1 L_xr47
  s_waitcnt vmcnt(7)
  s_cmp_ge_u32 s94, 46
  s_cbranch_scc1 L_xr47
  s_waitcnt vmcnt(6)
L_xr47:
  buffer_load_dwordx4 a[100:103], v5, s[36:39], s80 offen offset:2048 nt
  v_mfma_f32_16x16x32_bf16 v[80:83], a[72:75], v[92:95], v[80:83]
  s_waitcnt vmcnt(8)
  s_cmp_ge_u32 s94, 60
  s_cbranch_scc1 L_xr48
  s_waitcnt vmcnt(7)
  s_cmp_ge_u32 s94, 46
  s_cbranch_scc1 L_xr48
  s_waitcnt vmcnt(6)
L_xr48:
  buffer_load_dwordx4 a[104:107], v5, s[36:39], s80 offen offset:256 nt
  v_mfma_f32_16x16x32_bf16 v[84:87], a[76:79], v[92:95], v[84:87]
  s_mov_b32 s81, 344064
  buffer_load_ushort v200, v232, s[60:63], s81 offen offset:0
  buffer_load_ushort v204, v232, s[60:63], s81 offen offset:3584
  v_accvgpr_read_b32 v124, a192
  v_accvgpr_read_b32 v125, a196
  v_perm_b32 v126, v125, v124, s92
  v_perm_b32 v127, v125, v124, s100
  v_accvgpr_write_b32 a192, v126
  v_accvgpr_write_b32 a196, v127
  v_accvgpr_read_b32 v124, a193
  v_accvgpr_read_b32 v125, a197
  v_accvgpr_read_b32 v128, a200
  v_accvgpr_read_b32 v129, a204
  v_perm_b32 v126, v125, v124, s92
  v_perm_b32 v127, v125, v124, s100
  v_perm_b32 v130, v129, v128, s92
  v_perm_b32 v131, v129, v128, s100
  v_accvgpr_write_b32 a200, v126
  v_accvgpr_write_b32 a204, v127
  v_accvgpr_write_b32 a193, v130
  v_accvgpr_write_b32 a197, v131
  v_perm_b32 v96, v45, v45, v12
  v_perm_b32 v97, v45, v45, v13
  v_perm_b32 v98, v45, v45, v14
  v_perm_b32 v99, v45, v45, v15
  v_perm_b32 v100, v45, v45, v16
  v_perm_b32 v101, v45, v45, v17
  v_perm_b32 v102, v45, v45, v18
  v_perm_b32 v103, v45, v45, v19
  s_waitcnt vmcnt(10)
  s_cmp_ge_u32 s94, 60
  s_cbranch_scc1 L_xr49
  s_waitcnt vmcnt(9)
  s_cmp_ge_u32 s94, 46
  s_cbranch_scc1 L_xr49
  s_waitcnt vmcnt(8)
L_xr49:
  buffer_load_dwordx4 a[108:111], v5, s[36:39], s80 offen offset:2304 nt
  v_mfma_f32_16x16x32_bf16 v[80:83], a[80:83], v[96:99], v[80:83]
  s_waitcnt vmcnt(10)
  s_cmp_ge_u32 s94, 60
  s_cbranch_scc1 L_xr50
  s_waitcnt vmcnt(9)
  s_cmp_ge_u32 s94, 46
  s_cbranch_scc1 L_xr50
  s_waitcnt vmcnt(6)
L_xr50:
  s_mov_b32 s80, 245760
  buffer_load_dwordx4 a[112:115], v5, s[36:39], s80 offen offset:0 nt
  v_mfma_f32_16x16x32_bf16 v[84:87], a[84:87], v[96:99], v[84:87]
  s_waitcnt vmcnt(10)
  s_cmp_ge_u32 s94, 60
  s_cbranch_scc1 L_xr51
  s_waitcnt vmcnt(7)
  s_cmp_ge_u32 s94, 46
  s_cbranch_scc1 L_xr51
  s_waitcnt vmcnt(6)
L_xr51:
  buffer_load_dwordx4 a[116:119], v5, s[36:39], s80 offen offset:2048 nt
  v_mfma_f32_16x16x32_bf16 v[80:83], a[88:91], v[100:103], v[80:83]
  s_waitcnt vmcnt(8)
  s_cmp_ge_u32 s94, 60
  s_cbranch_scc1 L_xr52
  s_waitcnt vmcnt(7)
  s_cmp_ge_u32 s94, 46
  s_cbranch_scc1 L_xr52
  s_waitcnt vmcnt(6)
L_xr52:
  buffer_load_dwordx4 a[120:123], v5, s[36:39], s80 offen offset:256 nt
  v_mfma_f32_16x16x32_bf16 v[84:87], a[92:95], v[100:103], v[84:87]
  s_mov_b32 s81, 372736
  buffer_load_ushort v201, v232, s[60:63], s81 offen offset:0
  buffer_load_ushort v205, v232, s[60:63], s81 offen offset:3584
  v_accvgpr_read_b32 v124, a194
  v_accvgpr_read_b32 v125, a198
  v_accvgpr_read_b32 v128, a208
  v_accvgpr_read_b32 v129, a212
  v_perm_b32 v126, v125, v124, s92
  v_perm_b32 v127, v125, v124, s100
  v_perm_b32 v130, v129, v128, s92
  v_perm_b32 v131, v129, v128, s100
  v_accvgpr_write_b32 a208, v126
  v_accvgpr_write_b32 a212, v127
  v_accvgpr_write_b32 a194, v130
  v_accvgpr_write_b32 a198, v131
  v_accvgpr_read_b32 v124, a195
  v_accvgpr_read_b32 v125, a199
  v_accvgpr_read_b32 v128, a216
  v_accvgpr_read_b32 v129, a220
  v_perm_b32 v126, v125, v124, s92
  v_perm_b32 v127, v125, v124, s100
  v_perm_b32 v130, v129, v128, s92
  v_perm_b32 v131, v129, v128, s100
  v_accvgpr_write_b32 a216, v126
  v_accvgpr_write_b32 a220, v127
  v_accvgpr_write_b32 a195, v130
  v_accvgpr_write_b32 a199, v131
  v_perm_b32 v88, v46, v46, v12
  v_perm_b32 v89, v46, v46, v13
  v_perm_b32 v90, v46, v46, v14
  v_perm_b32 v91, v46, v46, v15
  v_perm_b32 v92, v46, v46, v16
  v_perm_b32 v93, v46, v46, v17
  v_perm_b32 v94, v46, v46, v18
  v_perm_b32 v95, v46, v46, v19
  s_waitcnt vmcnt(10)
  s_cmp_ge_u32 s94, 60
  s_cbranch_scc1 L_xr53
  s_waitcnt vmcnt(9)
  s_cmp_ge_u32 s94, 46
  s_cbranch_scc1 L_xr53
  s_waitcnt vmcnt(8)
L_xr53:
  buffer_load_dwordx4 a[124:127], v5, s[36:39], s80 offen offset:2304 nt
  v_mfma_f32_16x16x32_bf16 v[80:83], a[96:99], v[88:91], v[80:83]
  s_waitcnt vmcnt(10)
  s_cmp_ge_u32 s94, 60
  s_cbranch_scc1 L_xr54
  s_waitcnt vmcnt(9)
  s_cmp_ge_u32 s94, 46
  s_cbranch_scc1 L_xr54
  s_waitcnt vmcnt(6)
L_xr54:
  s_mov_b32 s80, 262144
  buffer_load_dwordx4 a[0:3], v5, s[36:39], s80 offen offset:0 nt
  v_mfma_f32_16x16x32_bf16 v[84:87], a[100:103], v[88:91], v[84:87]
  s_waitcnt vmcnt(10)
  s_cmp_ge_u32 s94, 60
  s_cbranch_scc1 L_xr55
  s_waitcnt vmcnt(7)
  s_cmp_ge_u32 s94, 46
  s_cbranch_scc1 L_xr55
  s_waitcnt vmcnt(6)
L_xr55:
  buffer_load_dwordx4 a[4:7], v5, s[36:39], s80 offen offset:2048 nt
  v_mfma_f32_16x16x32_bf16 v[80:83], a[104:107], v[92:95], v[80:83]
  s_waitcnt vmcnt(8)
  s_cmp_ge_u32 s94, 60
  s_cbranch_scc1 L_xr56
  s_waitcnt vmcnt(7)
  s_cmp_ge_u32 s94, 46
  s_cbranch_scc1 L_xr56
  s_waitcnt vmcnt(6)
L_xr56:
  buffer_load_dwordx4 a[8:11], v5, s[36:39], s80 offen offset:256 nt
  v_mfma_f32_16x16x32_bf16 v[84:87], a[108:111], v[92:95], v[84:87]
  s_mov_b32 s81, 401408
  buffer_load_ushort v202, v232, s[60:63], s81 offen offset:0
  buffer_load_ushort v206, v232, s[60:63], s81 offen offset:3584
  v_accvgpr_read_b32 v124, a201
  v_accvgpr_read_b32 v125, a205
  v_perm_b32 v126, v125, v124, s92
  v_perm_b32 v127, v125, v124, s100
  v_accvgpr_write_b32 a201, v126
  v_accvgpr_write_b32 a205, v127
  v_lshlrev_b32 v129, 5, v1
  v_mov_b32 v130, 2146435072
  v_cmp_gt_u32 vcc, 4, v1
  s_nop 1
  v_cndmask_b32 v129, v130, v129, vcc
  buffer_load_dword v212, v129, s[52:55], 0 offen sc1
  v_perm_b32 v96, v47, v47, v12
  v_perm_b32 v97, v47, v47, v13
  v_perm_b32 v98, v47, v47, v14
  v_perm_b32 v99, v47, v47, v15
  v_perm_b32 v100, v47, v47, v16
  v_perm_b32 v101, v47, v47, v17
  v_perm_b32 v102, v47, v47, v18
  v_perm_b32 v103, v47, v47, v19
  s_waitcnt vmcnt(11)
  s_cmp_ge_u32 s94, 60
  s_cbranch_scc1 L_xr57
  s_waitcnt vmcnt(10)
  s_cmp_ge_u32 s94, 46
  s_cbranch_scc1 L_xr57
  s_waitcnt vmcnt(9)
L_xr57:
  buffer_load_dwordx4 a[12:15], v5, s[36:39], s80 offen offset:2304 nt
  v_mfma_f32_16x16x32_bf16 v[80:83], a[112:115], v[96:99], v[80:83]
  s_waitcnt vmcnt(11)
  s_cmp_ge_u32 s94, 60
  s_cbranch_scc1 L_xr58
  s_waitcnt vmcnt(10)
  s_cmp_ge_u32 s94, 46
  s_cbranch_scc1 L_xr58
  s_waitcnt vmcnt(7)
L_xr58:
  s_mov_b32 s80, 278528
  buffer_load_dwordx4 a[16:19], v5, s[36:39], s80 offen offset:0 nt
  v_mfma_f32_16x16x32_bf16 v[84:87], a[116:119], v[96:99], v[84:87]
  s_waitcnt vmcnt(11)
  s_cmp_ge_u32 s94, 60
  s_cbranch_scc1 L_xr59
  s_waitcnt vmcnt(8)
  s_cmp_ge_u32 s94, 46
  s_cbranch_scc1 L_xr59
  s_waitcnt vmcnt(7)
L_xr59:
  buffer_load_dwordx4 a[20:23], v5, s[36:39], s80 offen offset:2048 nt
  v_mfma_f32_16x16x32_bf16 v[80:83], a[120:123], v[100:103], v[80:83]
  s_waitcnt vmcnt(9)
  s_cmp_ge_u32 s94, 60
  s_cbranch_scc1 L_xr60
  s_waitcnt vmcnt(8)
  s_cmp_ge_u32 s94, 46
  s_cbranch_scc1 L_xr60
  s_waitcnt vmcnt(7)
L_xr60:
  buffer_load_dwordx4 a[24:27], v5, s[36:39], s80 offen offset:256 nt
  v_mfma_f32_16x16x32_bf16 v[84:87], a[124:127], v[100:103], v[84:87]
  s_mov_b32 s81, 430080
  buffer_load_ushort v203, v232, s[60:63], s81 offen offset:0
  buffer_load_ushort v207, v232, s[60:63], s81 offen offset:3584
  v_accvgpr_read_b32 v124, a202
  v_accvgpr_read_b32 v125, a206
  v_accvgpr_read_b32 v128, a209
  v_accvgpr_read_b32 v129, a213
  v_perm_b32 v126, v125, v124, s92
  v_perm_b32 v127, v125, v124, s100
  v_perm_b32 v130, v129, v128, s92
  v_perm_b32 v131, v129, v128, s100
  v_accvgpr_write_b32 a209, v126
  v_accvgpr_write_b32 a213, v127
  v_accvgpr_write_b32 a202, v130
  v_accvgpr_write_b32 a206, v131
  v_accvgpr_read_b32 v124, a203
  v_accvgpr_read_b32 v125, a207
  v_accvgpr_read_b32 v128, a217
  v_accvgpr_read_b32 v129, a221
  v_perm_b32 v126, v125, v124, s92
  v_perm_b32 v127, v125, v124, s100
  v_perm_b32 v130, v129, v128, s92
  v_perm_b32 v131, v129, v128, s100
  v_accvgpr_write_b32 a217, v126
  v_accvgpr_write_b32 a221, v127
  v_accvgpr_write_b32 a203, v130
  v_accvgpr_write_b32 a207, v131
  v_perm_b32 v88, v48, v48, v12
  v_perm_b32 v89, v48, v48, v13
  v_perm_b32 v90, v48, v48, v14
  v_perm_b32 v91, v48, v48, v15
  v_perm_b32 v92, v48, v48, v16
  v_perm_b32 v93, v48, v48, v17
  v_perm_b32 v94, v48, v48, v18
  v_perm_b32 v95, v48, v48, v19
  s_waitcnt vmcnt(11)
  s_cmp_ge_u32 s94, 60
  s_cbranch_scc1 L_xr61
  s_waitcnt vmcnt(10)
  s_cmp_ge_u32 s94, 46
  s_cbranch_scc1 L_xr61
  s_waitcnt vmcnt(9)
L_xr61:
  buffer_load_dwordx4 a[28:31], v5, s[36:39], s80 offen offset:2304 nt
  v_mfma_f32_16x16x32_bf16 v[80:83], a[0:3], v[88:91], v[80:83]
  s_waitcnt vmcnt(11)
  s_cmp_ge_u32 s94, 60
  s_cbranch_scc1 L_xr62
  s_waitcnt vmcnt(10)
  s_cmp_ge_u32 s94, 46
  s_cbranch_scc1 L_xr62
  s_waitcnt vmcnt(6)
L_xr62:
  s_mov_b32 s80, 294912
  buffer_load_dwordx4 a[32:35], v5, s[36:39], s80 offen offset:0 nt
  v_mfma_f32_16x16x32_bf16 v[84:87], a[4:7], v[88:91], v[84:87]
  s_waitcnt vmcnt(11)
  s_cmp_ge_u32 s94, 60
  s_cbranch_scc1 L_xr63
  s_waitcnt vmcnt(7)
  s_cmp_ge_u32 s94, 46
  s_cbranch_scc1 L_xr63
  s_waitcnt vmcnt(6)
L_xr63:
  buffer_load_dwordx4 a[36:39], v5, s[36:39], s80 offen offset:2048 nt
  v_mfma_f32_16x16x32_bf16 v[80:83], a[8:11], v[92:95], v[80:83]
  s_waitcnt vmcnt(8)
  s_cmp_ge_u32 s94, 60
  s_cbranch_scc1 L_xr64
  s_waitcnt vmcnt(7)
  s_cmp_ge_u32 s94, 46
  s_cbranch_scc1 L_xr64
  s_waitcnt vmcnt(6)
L_xr64:
  buffer_load_dwordx4 a[40:43], v5, s[36:39], s80 offen offset:256 nt
  v_mfma_f32_16x16x32_bf16 v[84:87], a[12:15], v[92:95], v[84:87]
  buffer_load_dwordx4 v[160:163], v233, s[64:67], 0 offen offset:0
  buffer_load_dwordx4 v[164:167], v233, s[64:67], 0 offen offset:1024
  buffer_load_dwordx4 v[168:171], v233, s[64:67], 0 offen offset:2048
  buffer_load_dwordx4 v[172:175], v233, s[64:67], 0 offen offset:3072
  buffer_load_ushort v213, v234, s[68:71], 0 offen
  buffer_load_ushort v214, v243, s[56:59], 0 offen
  buffer_load_ushort v215, v240, s[72:75], 0 offen
  v_accvgpr_read_b32 v124, a210
  v_accvgpr_read_b32 v125, a214
  v_perm_b32 v126, v125, v124, s92
  v_perm_b32 v127, v125, v124, s100
  v_accvgpr_write_b32 a210, v126
  v_accvgpr_write_b32 a214, v127
  v_accvgpr_read_b32 v124, a211
  v_accvgpr_read_b32 v125, a215
  v_accvgpr_read_b32 v128, a218
  v_accvgpr_read_b32 v129, a222
  v_perm_b32 v126, v125, v124, s92
  v_perm_b32 v127, v125, v124, s100
  v_perm_b32 v130, v129, v128, s92
  v_perm_b32 v131, v129, v128, s100
  v_accvgpr_write_b32 a218, v126
  v_accvgpr_write_b32 a222, v127
  v_accvgpr_write_b32 a211, v130
  v_accvgpr_write_b32 a215, v131
  v_perm_b32 v96, v49, v49, v12
  v_perm_b32 v97, v49, v49, v13
  v_perm_b32 v98, v49, v49, v14
  v_perm_b32 v99, v49, v49, v15
  v_perm_b32 v100, v49, v49, v16
  v_perm_b32 v101, v49, v49, v17
  v_perm_b32 v102, v49, v49, v18
  v_perm_b32 v103, v49, v49, v19
  s_waitcnt vmcnt(15)
  s_cmp_ge_u32 s94, 60
  s_cbranch_scc1 L_xr65
  s_waitcnt vmcnt(14)
  s_cmp_ge_u32 s94, 46
  s_cbranch_scc1 L_xr65
  s_waitcnt vmcnt(13)
L_xr65:
  buffer_load_dwordx4 a[44:47], v5, s[36:39], s80 offen offset:2304 nt
  v_mfma_f32_16x16x32_bf16 v[80:83], a[16:19], v[96:99], v[80:83]
  s_waitcnt vmcnt(15)
  s_cmp_ge_u32 s94, 60
  s_cbranch_scc1 L_xr66
  s_waitcnt vmcnt(14)
  s_cmp_ge_u32 s94, 46
  s_cbranch_scc1 L_xr66
  s_waitcnt vmcnt(11)
L_xr66:
  s_mov_b32 s80, 311296
  buffer_load_dwordx4 a[48:51], v5, s[36:39], s80 offen offset:0 nt
  v_mfma_f32_16x16x32_bf16 v[84:87], a[20:23], v[96:99], v[84:87]
  s_waitcnt vmcnt(15)
  s_cmp_ge_u32 s94, 60
  s_cbranch_scc1 L_xr67
  s_waitcnt vmcnt(12)
  s_cmp_ge_u32 s94, 46
  s_cbranch_scc1 L_xr67
  s_waitcnt vmcnt(11)
L_xr67:
  buffer_load_dwordx4 a[52:55], v5, s[36:39], s80 offen offset:2048 nt
  v_mfma_f32_16x16x32_bf16 v[80:83], a[24:27], v[100:103], v[80:83]
  s_waitcnt vmcnt(13)
  s_cmp_ge_u32 s94, 60
  s_cbranch_scc1 L_xr68
  s_waitcnt vmcnt(12)
  s_cmp_ge_u32 s94, 46
  s_cbranch_scc1 L_xr68
  s_waitcnt vmcnt(11)
L_xr68:
  buffer_load_dwordx4 a[56:59], v5, s[36:39], s80 offen offset:256 nt
  v_mfma_f32_16x16x32_bf16 v[84:87], a[28:31], v[100:103], v[84:87]
  v_accvgpr_read_b32 v124, a219
  v_accvgpr_read_b32 v125, a223
  v_perm_b32 v126, v125, v124, s92
  v_perm_b32 v127, v125, v124, s100
  v_accvgpr_write_b32 a219, v126
  v_accvgpr_write_b32 a223, v127
  s_waitcnt vmcnt(21)
  s_mov_b32 s87, 32768
L_cnt:
  v_cmp_gt_u32 vcc, 64, v212
  s_and_b32 vcc_lo, vcc_lo, 15
  s_cbranch_scc0 L_cnt_ok
  s_sub_u32 s87, s87, 1
  s_cbranch_scc1 L_cnt_ok
  v_lshlrev_b32 v129, 5, v1
  v_mov_b32 v130, 2146435072
  v_cmp_gt_u32 vcc, 4, v1
  s_nop 1
  v_cndmask_b32 v129, v130, v129, vcc
  buffer_load_dword v212, v129, s[52:55], 0 offen sc1
  s_waitcnt vmcnt(0)
  s_branch L_cnt
L_cnt_ok:
  s_cmp_lt_u32 s2, 32
  s_cbranch_scc0 L_eup
  s_cmp_eq_u32 s3, 0
  s_cbranch_scc0 L_eup
  v_mov_b32 v124, 2146435072
  v_cmp_eq_u32 vcc, 0, v1
  s_nop 1
  v_cndmask_b32 v124, v124, v148, vcc
  buffer_store_dwordx2 v[144:145], v124, s[48:51], 0 offen sc1
L_eup:
  buffer_load_dwordx2 v[210:211], v10, s[48:51], 0 offen sc1
  v_perm_b32 v88, v50, v50, v12
  v_perm_b32 v89, v50, v50, v13
  v_perm_b32 v90, v50, v50, v14
  v_perm_b32 v91, v50, v50, v15
  v_perm_b32 v92, v50, v50, v16
  v_perm_b32 v93, v50, v50, v17
  v_perm_b32 v94, v50, v50, v18
  v_perm_b32 v95, v50, v50, v19
  s_waitcnt vmcnt(14)
  s_cmp_ge_u32 s94, 60
  s_cbranch_scc1 L_xr69
  s_waitcnt vmcnt(13)
  s_cmp_ge_u32 s94, 46
  s_cbranch_scc1 L_xr69
  s_waitcnt vmcnt(12)
L_xr69:
  buffer_load_dwordx4 a[60:63], v5, s[36:39], s80 offen offset:2304 nt
  v_mfma_f32_16x16x32_bf16 v[80:83], a[32:35], v[88:91], v[80:83]
  s_waitcnt vmcnt(14)
  s_cmp_ge_u32 s94, 60
  s_cbranch_scc1 L_xr70
  s_waitcnt vmcnt(13)
  s_cmp_ge_u32 s94, 46
  s_cbranch_scc1 L_xr70
  s_waitcnt vmcnt(5)
L_xr70:
  s_mov_b32 s80, 327680
  buffer_load_dwordx4 a[64:67], v5, s[36:39], s80 offen offset:0 nt
  v_mfma_f32_16x16x32_bf16 v[84:87], a[36:39], v[88:91], v[84:87]
  s_waitcnt vmcnt(14)
  s_cmp_ge_u32 s94, 60
  s_cbranch_scc1 L_xr71
  s_waitcnt vmcnt(6)
  s_cmp_ge_u32 s94, 46
  s_cbranch_scc1 L_xr71
  s_waitcnt vmcnt(5)
L_xr71:
  buffer_load_dwordx4 a[68:71], v5, s[36:39], s80 offen offset:2048 nt
  v_mfma_f32_16x16x32_bf16 v[80:83], a[40:43], v[92:95], v[80:83]
  s_waitcnt vmcnt(7)
  s_cmp_ge_u32 s94, 60
  s_cbranch_scc1 L_xr72
  s_waitcnt vmcnt(6)
  s_cmp_ge_u32 s94, 46
  s_cbranch_scc1 L_xr72
  s_waitcnt vmcnt(5)
L_xr72:
  buffer_load_dwordx4 a[72:75], v5, s[36:39], s80 offen offset:256 nt
  v_mfma_f32_16x16x32_bf16 v[84:87], a[44:47], v[92:95], v[84:87]
  v_accvgpr_read_b32 v124, a224
  v_accvgpr_read_b32 v125, a228
  v_perm_b32 v126, v125, v124, s92
  v_perm_b32 v127, v125, v124, s100
  v_accvgpr_write_b32 a224, v126
  v_accvgpr_write_b32 a228, v127
  v_accvgpr_read_b32 v124, a225
  v_accvgpr_read_b32 v125, a229
  v_accvgpr_read_b32 v128, a232
  v_accvgpr_read_b32 v129, a236
  v_perm_b32 v126, v125, v124, s92
  v_perm_b32 v127, v125, v124, s100
  v_perm_b32 v130, v129, v128, s92
  v_perm_b32 v131, v129, v128, s100
  v_accvgpr_write_b32 a232, v126
  v_accvgpr_write_b32 a236, v127
  v_accvgpr_write_b32 a225, v130
  v_accvgpr_write_b32 a229, v131
  v_perm_b32 v96, v51, v51, v12
  v_perm_b32 v97, v51, v51, v13
  v_perm_b32 v98, v51, v51, v14
  v_perm_b32 v99, v51, v51, v15
  v_perm_b32 v100, v51, v51, v16
  v_perm_b32 v101, v51, v51, v17
  v_perm_b32 v102, v51, v51, v18
  v_perm_b32 v103, v51, v51, v19
  s_waitcnt vmcnt(7)
  s_cmp_ge_u32 s94, 60
  s_cbranch_scc1 L_xr73
  s_waitcnt vmcnt(6)
  s_cmp_ge_u32 s94, 46
  s_cbranch_scc1 L_xr73
  s_waitcnt vmcnt(5)
L_xr73:
  buffer_load_dwordx4 a[76:79], v5, s[36:39], s80 offen offset:2304 nt
  v_mfma_f32_16x16x32_bf16 v[80:83], a[48:51], v[96:99], v[80:83]
  s_waitcnt vmcnt(7)
  s_cmp_ge_u32 s94, 60
  s_cbranch_scc1 L_xr74
  s_waitcnt vmcnt(6)
  s_cmp_ge_u32 s94, 46
  s_cbranch_scc1 L_xr74
  s_waitcnt vmcnt(4)
L_xr74:
  s_mov_b32 s80, 344064
  buffer_load_dwordx4 a[80:83], v5, s[36:39], s80 offen offset:0 nt
  v_mfma_f32_16x16x32_bf16 v[84:87], a[52:55], v[96:99], v[84:87]
  s_waitcnt vmcnt(7)
  s_cmp_ge_u32 s94, 60
  s_cbranch_scc1 L_xr75
  s_waitcnt vmcnt(5)
  s_cmp_ge_u32 s94, 46
  s_cbranch_scc1 L_xr75
  s_waitcnt vmcnt(4)
L_xr75:
  buffer_load_dwordx4 a[84:87], v5, s[36:39], s80 offen offset:2048 nt
  v_mfma_f32_16x16x32_bf16 v[80:83], a[56:59], v[100:103], v[80:83]
  s_waitcnt vmcnt(6)
  s_cmp_ge_u32 s94, 60
  s_cbranch_scc1 L_xr76
  s_waitcnt vmcnt(5)
  s_cmp_ge_u32 s94, 46
  s_cbranch_scc1 L_xr76
  s_waitcnt vmcnt(4)
L_xr76:
  buffer_load_dwordx4 a[88:91], v5, s[36:39], s80 offen offset:256 nt
  v_mfma_f32_16x16x32_bf16 v[84:87], a[60:63], v[100:103], v[84:87]
  v_accvgpr_read_b32 v124, a226
  v_accvgpr_read_b32 v125, a230
  v_accvgpr_read_b32 v128, a240
  v_accvgpr_read_b32 v129, a244
  v_perm_b32 v126, v125, v124, s92
  v_perm_b32 v127, v125, v124, s100
  v_perm_b32 v130, v129, v128, s92
  v_perm_b32 v131, v129, v128, s100
  v_accvgpr_write_b32 a240, v126
  v_accvgpr_write_b32 a244, v127
  v_accvgpr_write_b32 a226, v130
  v_accvgpr_write_b32 a230, v131
  v_accvgpr_read_b32 v124, a227
  v_accvgpr_read_b32 v125, a231
  v_accvgpr_read_b32 v128, a248
  v_accvgpr_read_b32 v129, a252
  v_perm_b32 v126, v125, v124, s92
  v_perm_b32 v127, v125, v124, s100
  v_perm_b32 v130, v129, v128, s92
  v_perm_b32 v131, v129, v128, s100
  v_accvgpr_write_b32 a248, v126
  v_accvgpr_write_b32 a252, v127
  v_accvgpr_write_b32 a227, v130
  v_accvgpr_write_b32 a231, v131
  v_perm_b32 v88, v52, v52, v12
  v_perm_b32 v89, v52, v52, v13
  v_perm_b32 v90, v52, v52, v14
  v_perm_b32 v91, v52, v52, v15
  v_perm_b32 v92, v52, v52, v16
  v_perm_b32 v93, v52, v52, v17
  v_perm_b32 v94, v52, v52, v18
  v_perm_b32 v95, v52, v52, v19
  s_waitcnt vmcnt(6)
  s_cmp_ge_u32 s94, 60
  s_cbranch_scc1 L_xr77
  s_waitcnt vmcnt(5)
  s_cmp_ge_u32 s94, 46
  s_cbranch_scc1 L_xr77
  s_waitcnt vmcnt(4)
L_xr77:
  buffer_load_dwordx4 a[92:95], v5, s[36:39], s80 offen offset:2304 nt
  v_mfma_f32_16x16x32_bf16 v[80:83], a[64:67], v[88:91], v[80:83]
  s_waitcnt vmcnt(6)
  s_cmp_ge_u32 s94, 60
  s_cbranch_scc1 L_xr78
  s_waitcnt vmcnt(5)
  s_cmp_ge_u32 s94, 46
  s_cbranch_scc1 L_xr78
  s_waitcnt vmcnt(4)
L_xr78:
  s_mov_b32 s80, 360448
  buffer_load_dwordx4 a[96:99], v5, s[36:39], s80 offen offset:0 nt
  v_mfma_f32_16x16x32_bf16 v[84:87], a[68:71], v[88:91], v[84:87]
  s_waitcnt vmcnt(6)
  s_cmp_ge_u32 s94, 60
  s_cbranch_scc1 L_xr79
  s_waitcnt vmcnt(5)
  s_cmp_ge_u32 s94, 46
  s_cbranch_scc1 L_xr79
  s_waitcnt vmcnt(4)
L_xr79:
  buffer_load_dwordx4 a[100:103], v5, s[36:39], s80 offen offset:2048 nt
  v_mfma_f32_16x16x32_bf16 v[80:83], a[72:75], v[92:95], v[80:83]
  s_waitcnt vmcnt(6)
  s_cmp_ge_u32 s94, 60
  s_cbranch_scc1 L_xr80
  s_waitcnt vmcnt(5)
  s_cmp_ge_u32 s94, 46
  s_cbranch_scc1 L_xr80
  s_waitcnt vmcnt(4)
L_xr80:
  buffer_load_dwordx4 a[104:107], v5, s[36:39], s80 offen offset:256 nt
  v_mfma_f32_16x16x32_bf16 v[84:87], a[76:79], v[92:95], v[84:87]
  v_accvgpr_read_b32 v124, a233
  v_accvgpr_read_b32 v125, a237
  v_perm_b32 v126, v125, v124, s92
  v_perm_b32 v127, v125, v124, s100
  v_accvgpr_write_b32 a233, v126
  v_accvgpr_write_b32 a237, v127
  v_perm_b32 v96, v53, v53, v12
  v_perm_b32 v97, v53, v53, v13
  v_perm_b32 v98, v53, v53, v14
  v_perm_b32 v99, v53, v53, v15
  v_perm_b32 v100, v53, v53, v16
  v_perm_b32 v101, v53, v53, v17
  v_perm_b32 v102, v53, v53, v18
  v_perm_b32 v103, v53, v53, v19
  s_waitcnt vmcnt(6)
  s_cmp_ge_u32 s94, 60
  s_cbranch_scc1 L_xr81
  s_waitcnt vmcnt(5)
  s_cmp_ge_u32 s94, 46
  s_cbranch_scc1 L_xr81
  s_waitcnt vmcnt(4)
L_xr81:
  buffer_load_dwordx4 a[108:111], v5, s[36:39], s80 offen offset:2304 nt
  v_mfma_f32_16x16x32_bf16 v[80:83], a[80:83], v[96:99], v[80:83]
  s_waitcnt vmcnt(6)
  s_cmp_ge_u32 s94, 60
  s_cbranch_scc1 L_xr82
  s_waitcnt vmcnt(5)
  s_cmp_ge_u32 s94, 46
  s_cbranch_scc1 L_xr82
  s_waitcnt vmcnt(4)
L_xr82:
  s_mov_b32 s80, 376832
  buffer_load_dwordx4 a[112:115], v5, s[36:39], s80 offen offset:0 nt
  v_mfma_f32_16x16x32_bf16 v[84:87], a[84:87], v[96:99], v[84:87]
  s_waitcnt vmcnt(6)
  s_cmp_ge_u32 s94, 60
  s_cbranch_scc1 L_xr83
  s_waitcnt vmcnt(5)
  s_cmp_ge_u32 s94, 46
  s_cbranch_scc1 L_xr83
  s_waitcnt vmcnt(4)
L_xr83:
  buffer_load_dwordx4 a[116:119], v5, s[36:39], s80 offen offset:2048 nt
  v_mfma_f32_16x16x32_bf16 v[80:83], a[88:91], v[100:103], v[80:83]
  s_waitcnt vmcnt(6)
  s_cmp_ge_u32 s94, 60
  s_cbranch_scc1 L_xr84
  s_waitcnt vmcnt(5)
  s_cmp_ge_u32 s94, 46
  s_cbranch_scc1 L_xr84
  s_waitcnt vmcnt(4)
L_xr84:
  buffer_load_dwordx4 a[120:123], v5, s[36:39], s80 offen offset:256 nt
  v_mfma_f32_16x16x32_bf16 v[84:87], a[92:95], v[100:103], v[84:87]
  v_accvgpr_read_b32 v124, a234
  v_accvgpr_read_b32 v125, a238
  v_accvgpr_read_b32 v128, a241
  v_accvgpr_read_b32 v129, a245
  v_perm_b32 v126, v125, v124, s92
  v_perm_b32 v127, v125, v124, s100
  v_perm_b32 v130, v129, v128, s92
  v_perm_b32 v131, v129, v128, s100
  v_accvgpr_write_b32 a241, v126
  v_accvgpr_write_b32 a245, v127
  v_accvgpr_write_b32 a234, v130
  v_accvgpr_write_b32 a238, v131
  v_accvgpr_read_b32 v124, a235
  v_accvgpr_read_b32 v125, a239
  v_accvgpr_read_b32 v128, a249
  v_accvgpr_read_b32 v129, a253
  v_perm_b32 v126, v125, v124, s92
  v_perm_b32 v127, v125, v124, s100
  v_perm_b32 v130, v129, v128, s92
  v_perm_b32 v131, v129, v128, s100
  v_accvgpr_write_b32 a249, v126
  v_accvgpr_write_b32 a253, v127
  v_accvgpr_write_b32 a235, v130
  v_accvgpr_write_b32 a239, v131
  v_perm_b32 v88, v54, v54, v12
  v_perm_b32 v89, v54, v54, v13
  v_perm_b32 v90, v54, v54, v14
  v_perm_b32 v91, v54, v54, v15
  v_perm_b32 v92, v54, v54, v16
  v_perm_b32 v93, v54, v54, v17
  v_perm_b32 v94, v54, v54, v18
  v_perm_b32 v95, v54, v54, v19
  s_waitcnt vmcnt(6)
  s_cmp_ge_u32 s94, 60
  s_cbranch_scc1 L_xr85
  s_waitcnt vmcnt(5)
  s_cmp_ge_u32 s94, 46
  s_cbranch_scc1 L_xr85
  s_waitcnt vmcnt(4)
L_xr85:
  buffer_load_dwordx4 a[124:127], v5, s[36:39], s80 offen offset:2304 nt
  v_mfma_f32_16x16x32_bf16 v[80:83], a[96:99], v[88:91], v[80:83]
  s_waitcnt vmcnt(6)
  s_cmp_ge_u32 s94, 60
  s_cbranch_scc1 L_xr86
  s_waitcnt vmcnt(5)
  s_cmp_ge_u32 s94, 46
  s_cbranch_scc1 L_xr86
  s_waitcnt vmcnt(4)
L_xr86:
  s_mov_b32 s80, 393216
  buffer_load_dwordx4 a[0:3], v5, s[36:39], s80 offen offset:0 nt
  v_mfma_f32_16x16x32_bf16 v[84:87], a[100:103], v[88:91], v[84:87]
  s_waitcnt vmcnt(6)
  s_cmp_ge_u32 s94, 60
  s_cbranch_scc1 L_xr87
  s_waitcnt vmcnt(5)
  s_cmp_ge_u32 s94, 46
  s_cbranch_scc1 L_xr87
  s_waitcnt vmcnt(4)
L_xr87:
  buffer_load_dwordx4 a[4:7], v5, s[36:39], s80 offen offset:2048 nt
  v_mfma_f32_16x16x32_bf16 v[80:83], a[104:107], v[92:95], v[80:83]
  s_waitcnt vmcnt(6)
  s_cmp_ge_u32 s94, 60
  s_cbranch_scc1 L_xr88
  s_waitcnt vmcnt(5)
  s_cmp_ge_u32 s94, 46
  s_cbranch_scc1 L_xr88
  s_waitcnt vmcnt(4)
L_xr88:
  buffer_load_dwordx4 a[8:11], v5, s[36:39], s80 offen offset:256 nt
  v_mfma_f32_16x16x32_bf16 v[84:87], a[108:111], v[92:95], v[84:87]
  v_accvgpr_read_b32 v124, a242
  v_accvgpr_read_b32 v125, a246
  v_perm_b32 v126, v125, v124, s92
  v_perm_b32 v127, v125, v124, s100
  v_accvgpr_write_b32 a242, v126
  v_accvgpr_write_b32 a246, v127
  v_accvgpr_read_b32 v124, a243
  v_accvgpr_read_b32 v125, a247
  v_accvgpr_read_b32 v128, a250
  v_accvgpr_read_b32 v129, a254
  v_perm_b32 v126, v125, v124, s92
  v_perm_b32 v127, v125, v124, s100
  v_perm_b32 v130, v129, v128, s92
  v_perm_b32 v131, v129, v128, s100
  v_accvgpr_write_b32 a250, v126
  v_accvgpr_write_b32 a254, v127
  v_accvgpr_write_b32 a243, v130
  v_accvgpr_write_b32 a247, v131
  v_perm_b32 v96, v55, v55, v12
  v_perm_b32 v97, v55, v55, v13
  v_perm_b32 v98, v55, v55, v14
  v_perm_b32 v99, v55, v55, v15
  v_perm_b32 v100, v55, v55, v16
  v_perm_b32 v101, v55, v55, v17
  v_perm_b32 v102, v55, v55, v18
  v_perm_b32 v103, v55, v55, v19
  s_waitcnt vmcnt(6)
  s_cmp_ge_u32 s94, 60
  s_cbranch_scc1 L_xr89
  s_waitcnt vmcnt(5)
  s_cmp_ge_u32 s94, 46
  s_cbranch_scc1 L_xr89
  s_waitcnt vmcnt(4)
L_xr89:
  buffer_load_dwordx4 a[12:15], v5, s[36:39], s80 offen offset:2304 nt
  v_mfma_f32_16x16x32_bf16 v[80:83], a[112:115], v[96:99], v[80:83]
  s_waitcnt vmcnt(6)
  s_cmp_ge_u32 s94, 60
  s_cbranch_scc1 L_xr90
  s_waitcnt vmcnt(5)
  s_cmp_ge_u32 s94, 46
  s_cbranch_scc1 L_xr90
  s_waitcnt vmcnt(4)
L_xr90:
  s_mov_b32 s80, 409600
  buffer_load_dwordx4 a[16:19], v5, s[36:39], s80 offen offset:0 nt
  v_mfma_f32_16x16x32_bf16 v[84:87], a[116:119], v[96:99], v[84:87]
  s_waitcnt vmcnt(6)
  s_cmp_ge_u32 s94, 60
  s_cbranch_scc1 L_xr91
  s_waitcnt vmcnt(5)
  s_cmp_ge_u32 s94, 46
  s_cbranch_scc1 L_xr91
  s_waitcnt vmcnt(4)
L_xr91:
  buffer_load_dwordx4 a[20:23], v5, s[36:39], s80 offen offset:2048 nt
  v_mfma_f32_16x16x32_bf16 v[80:83], a[120:123], v[100:103], v[80:83]
  s_waitcnt vmcnt(6)
  s_cmp_ge_u32 s94, 60
  s_cbranch_scc1 L_xr92
  s_waitcnt vmcnt(5)
  s_cmp_ge_u32 s94, 46
  s_cbranch_scc1 L_xr92
  s_waitcnt vmcnt(4)
L_xr92:
  buffer_load_dwordx4 a[24:27], v5, s[36:39], s80 offen offset:256 nt
  v_mfma_f32_16x16x32_bf16 v[84:87], a[124:127], v[100:103], v[84:87]
  v_accvgpr_read_b32 v124, a251
  v_accvgpr_read_b32 v125, a255
  v_perm_b32 v126, v125, v124, s92
  v_perm_b32 v127, v125, v124, s100
  v_accvgpr_write_b32 a251, v126
  v_accvgpr_write_b32 a255, v127
  v_perm_b32 v88, v56, v56, v12
  v_perm_b32 v89, v56, v56, v13
  v_perm_b32 v90, v56, v56, v14
  v_perm_b32 v91, v56, v56, v15
  v_perm_b32 v92, v56, v56, v16
  v_perm_b32 v93, v56, v56, v17
  v_perm_b32 v94, v56, v56, v18
  v_perm_b32 v95, v56, v56, v19
  s_waitcnt vmcnt(6)
  s_cmp_ge_u32 s94, 60
  s_cbranch_scc1 L_xr93
  s_waitcnt vmcnt(5)
  s_cmp_ge_u32 s94, 46
  s_cbranch_scc1 L_xr93
  s_waitcnt vmcnt(4)
L_xr93:
  buffer_load_dwordx4 a[28:31], v5, s[36:39], s80 offen offset:2304 nt
  v_mfma_f32_16x16x32_bf16 v[80:83], a[0:3], v[88:91], v[80:83]
  s_waitcnt vmcnt(6)
  s_cmp_ge_u32 s94, 60
  s_cbranch_scc1 L_xr94
  s_waitcnt vmcnt(5)
  s_cmp_ge_u32 s94, 46
  s_cbranch_scc1 L_xr94
  s_waitcnt vmcnt(4)
L_xr94:
  s_mov_b32 s80, 425984
  buffer_load_dwordx4 a[32:35], v5, s[36:39], s80 offen offset:0 nt
  v_mfma_f32_16x16x32_bf16 v[84:87], a[4:7], v[88:91], v[84:87]
  s_waitcnt vmcnt(6)
  s_cmp_ge_u32 s94, 60
  s_cbranch_scc1 L_xr95
  s_waitcnt vmcnt(5)
  s_cmp_ge_u32 s94, 46
  s_cbranch_scc1 L_xr95
  s_waitcnt vmcnt(4)
L_xr95:
  buffer_load_dwordx4 a[36:39], v5, s[36:39], s80 offen offset:2048 nt
  v_mfma_f32_16x16x32_bf16 v[80:83], a[8:11], v[92:95], v[80:83]
  s_waitcnt vmcnt(6)
  s_cmp_ge_u32 s94, 60
  s_cbranch_scc1 L_xr96
  s_waitcnt vmcnt(5)
  s_cmp_ge_u32 s94, 46
  s_cbranch_scc1 L_xr96
  s_waitcnt vmcnt(4)
L_xr96:
  buffer_load_dwordx4 a[40:43], v5, s[36:39], s80 offen offset:256 nt
  v_mfma_f32_16x16x32_bf16 v[84:87], a[12:15], v[92:95], v[84:87]
  v_perm_b32 v96, v57, v57, v12
  v_perm_b32 v97, v57, v57, v13
  v_perm_b32 v98, v57, v57, v14
  v_perm_b32 v99, v57, v57, v15
  v_perm_b32 v100, v57, v57, v16
  v_perm_b32 v101, v57, v57, v17
  v_perm_b32 v102, v57, v57, v18
  v_perm_b32 v103, v57, v57, v19
  s_waitcnt vmcnt(6)
  s_cmp_ge_u32 s94, 60
  s_cbranch_scc1 L_xr97
  s_waitcnt vmcnt(5)
  s_cmp_ge_u32 s94, 46
  s_cbranch_scc1 L_xr97
  s_waitcnt vmcnt(4)
L_xr97:
  buffer_load_dwordx4 a[44:47], v5, s[36:39], s80 offen offset:2304 nt
  v_mfma_f32_16x16x32_bf16 v[80:83], a[16:19], v[96:99], v[80:83]
  s_waitcnt vmcnt(6)
  s_cmp_ge_u32 s94, 60
  s_cbranch_scc1 L_xr98
  s_waitcnt vmcnt(5)
  s_cmp_ge_u32 s94, 46
  s_cbranch_scc1 L_xr98
  s_waitcnt vmcnt(4)
L_xr98:
  s_mov_b32 s80, 442368
  buffer_load_dwordx4 a[48:51], v5, s[36:39], s80 offen offset:0 nt
  v_mfma_f32_16x16x32_bf16 v[84:87], a[20:23], v[96:99], v[84:87]
  s_waitcnt vmcnt(6)
  s_cmp_ge_u32 s94, 60
  s_cbranch_scc1 L_xr99
  s_waitcnt vmcnt(5)
  s_cmp_ge_u32 s94, 46
  s_cbranch_scc1 L_xr99
  s_waitcnt vmcnt(4)
L_xr99:
  buffer_load_dwordx4 a[52:55], v5, s[36:39], s80 offen offset:2048 nt
  v_mfma_f32_16x16x32_bf16 v[80:83], a[24:27], v[100:103], v[80:83]
  s_waitcnt vmcnt(6)
  s_cmp_ge_u32 s94, 60
  s_cbranch_scc1 L_xr100
  s_waitcnt vmcnt(5)
  s_cmp_ge_u32 s94, 46
  s_cbranch_scc1 L_xr100
  s_waitcnt vmcnt(4)
L_xr100:
  buffer_load_dwordx4 a[56:59], v5, s[36:39], s80 offen offset:256 nt
  v_mfma_f32_16x16x32_bf16 v[84:87], a[28:31], v[100:103], v[84:87]
  s_waitcnt vmcnt(32)
  s_mov_b32 s87, 32768
L_ml:
  v_mov_b32 v134, v210
  s_nop 1
  v_max_f32_dpp v134, v134, v134 row_ror:1 row_mask:0xf bank_mask:0xf
  s_nop 1
  v_max_f32_dpp v134, v134, v134 row_ror:2 row_mask:0xf bank_mask:0xf
  s_nop 1
  v_max_f32_dpp v134, v134, v134 row_ror:4 row_mask:0xf bank_mask:0xf
  s_nop 1
  v_max_f32_dpp v134, v134, v134 row_ror:8 row_mask:0xf bank_mask:0xf
  v_sub_f32 v135, v210, v134
  v_mul_f32 v135, 1069066811, v135
  v_exp_f32 v135, v135
  s_nop 0
  v_mul_f32 v135, v135, v211
  s_nop 1
  v_add_f32_dpp v135, v135, v135 row_ror:1 row_mask:0xf bank_mask:0xf
  s_nop 1
  v_add_f32_dpp v135, v135, v135 row_ror:2 row_mask:0xf bank_mask:0xf
  s_nop 1
  v_add_f32_dpp v135, v135, v135 row_ror:4 row_mask:0xf bank_mask:0xf
  s_nop 1
  v_add_f32_dpp v135, v135, v135 row_ror:8 row_mask:0xf bank_mask:0xf
  v_sub_f32 v134, v142, v134
  v_mul_f32 v134, 1069066811, v134
  v_exp_f32 v134, v134
  v_rcp_f32 v136, v135
  s_nop 0
  v_mul_f32 v208, v134, v136
  v_cmp_u_f32 vcc, v135, v135
  s_cbranch_vccz L_ml_ok
  s_sub_u32 s87, s87, 1
  s_cbranch_scc1 L_ml_ok
  buffer_load_dwordx2 v[210:211], v10, s[48:51], 0 offen sc1
  s_waitcnt vmcnt(0)
  s_branch L_ml
L_ml_ok:
  v_perm_b32 v88, v58, v58, v12
  v_perm_b32 v89, v58, v58, v13
  v_perm_b32 v90, v58, v58, v14
  v_perm_b32 v91, v58, v58, v15
  v_perm_b32 v92, v58, v58, v16
  v_perm_b32 v93, v58, v58, v17
  v_perm_b32 v94, v58, v58, v18
  v_perm_b32 v95, v58, v58, v19
  s_waitcnt vmcnt(6)
  s_cmp_ge_u32 s94, 60
  s_cbranch_scc1 L_xr101
  s_waitcnt vmcnt(5)
  s_cmp_ge_u32 s94, 46
  s_cbranch_scc1 L_xr101
  s_waitcnt vmcnt(4)
L_xr101:
  buffer_load_dwordx4 a[60:63], v5, s[36:39], s80 offen offset:2304 nt
  v_mfma_f32_16x16x32_bf16 v[80:83], a[32:35], v[88:91], v[80:83]
  s_waitcnt vmcnt(6)
  s_cmp_ge_u32 s94, 60
  s_cbranch_scc1 L_xr102
  s_waitcnt vmcnt(5)
  s_cmp_ge_u32 s94, 46
  s_cbranch_scc1 L_xr102
  s_waitcnt vmcnt(4)
L_xr102:
  s_mov_b32 s80, 458752
  buffer_load_dwordx4 a[64:67], v5, s[36:39], s80 offen offset:0 nt
  v_mfma_f32_16x16x32_bf16 v[84:87], a[36:39], v[88:91], v[84:87]
  s_waitcnt vmcnt(6)
  s_cmp_ge_u32 s94, 60
  s_cbranch_scc1 L_xr103
  s_waitcnt vmcnt(5)
  s_cmp_ge_u32 s94, 46
  s_cbranch_scc1 L_xr103
  s_waitcnt vmcnt(4)
L_xr103:
  buffer_load_dwordx4 a[68:71], v5, s[36:39], s80 offen offset:2048 nt
  v_mfma_f32_16x16x32_bf16 v[80:83], a[40:43], v[92:95], v[80:83]
  s_waitcnt vmcnt(6)
  s_cmp_ge_u32 s94, 60
  s_cbranch_scc1 L_xr104
  s_waitcnt vmcnt(5)
  s_cmp_ge_u32 s94, 46
  s_cbranch_scc1 L_xr104
  s_waitcnt vmcnt(4)
L_xr104:
  buffer_load_dwordx4 a[72:75], v5, s[36:39], s80 offen offset:256 nt
  v_mfma_f32_16x16x32_bf16 v[84:87], a[44:47], v[92:95], v[84:87]
  v_perm_b32 v96, v59, v59, v12
  v_perm_b32 v97, v59, v59, v13
  v_perm_b32 v98, v59, v59, v14
  v_perm_b32 v99, v59, v59, v15
  v_perm_b32 v100, v59, v59, v16
  v_perm_b32 v101, v59, v59, v17
  v_perm_b32 v102, v59, v59, v18
  v_perm_b32 v103, v59, v59, v19
  s_waitcnt vmcnt(6)
  s_cmp_ge_u32 s94, 60
  s_cbranch_scc1 L_xr105
  s_waitcnt vmcnt(5)
  s_cmp_ge_u32 s94, 46
  s_cbranch_scc1 L_xr105
  s_waitcnt vmcnt(4)
L_xr105:
  buffer_load_dwordx4 a[76:79], v5, s[36:39], s80 offen offset:2304 nt
  s_mov_b32 s80, 475136
  buffer_load_dwordx4 a[80:83], v5, s[36:39], s80 offen offset:0 nt
  buffer_load_dwordx4 a[84:87], v5, s[36:39], s80 offen offset:2048 nt
  buffer_load_dwordx4 a[88:91], v5, s[36:39], s80 offen offset:256 nt
  buffer_load_dwordx4 a[92:95], v5, s[36:39], s80 offen offset:2304 nt
  s_mov_b32 s80, 491520
  buffer_load_dwordx4 a[96:99], v5, s[36:39], s80 offen offset:0 nt
  buffer_load_dwordx4 a[100:103], v5, s[36:39], s80 offen offset:2048 nt
  buffer_load_dwordx4 a[104:107], v5, s[36:39], s80 offen offset:256 nt
  buffer_load_dwordx4 a[108:111], v5, s[36:39], s80 offen offset:2304 nt
  s_mov_b32 s80, 507904
  buffer_load_dwordx4 a[112:115], v5, s[36:39], s80 offen offset:0 nt
  v_mfma_f32_16x16x32_bf16 v[80:83], a[48:51], v[96:99], v[80:83]
  s_waitcnt vmcnt(15)
  buffer_load_dwordx4 a[116:119], v5, s[36:39], s80 offen offset:2048 nt
  v_mfma_f32_16x16x32_bf16 v[84:87], a[52:55], v[96:99], v[84:87]
  s_waitcnt vmcnt(15)
  buffer_load_dwordx4 a[120:123], v5, s[36:39], s80 offen offset:256 nt
  v_mfma_f32_16x16x32_bf16 v[80:83], a[56:59], v[100:103], v[80:83]
  s_waitcnt vmcnt(15)
  buffer_load_dwordx4 a[124:127], v5, s[36:39], s80 offen offset:2304 nt
  v_mfma_f32_16x16x32_bf16 v[84:87], a[60:63], v[100:103], v[84:87]
  s_cmp_eq_u32 s86, 1
  s_cbranch_scc0 L_pk1
  v_perm_b32 v144, v177, v176, s92
  v_perm_b32 v145, v179, v178, s92
  v_perm_b32 v146, v181, v180, s92
  v_perm_b32 v147, v183, v182, s92
  v_perm_b32 v148, v185, v184, s92
  v_perm_b32 v149, v187, v186, s92
  v_perm_b32 v150, v189, v188, s92
  v_perm_b32 v151, v191, v190, s92
  v_perm_b32 v152, v193, v192, s92
  v_perm_b32 v153, v195, v194, s92
  v_perm_b32 v154, v197, v196, s92
  v_perm_b32 v155, v199, v198, s92
  v_perm_b32 v156, v201, v200, s92
  v_perm_b32 v157, v203, v202, s92
  v_perm_b32 v158, v205, v204, s92
  v_perm_b32 v159, v207, v206, s92
L_pk1:
  v_perm_b32 v88, v60, v60, v12
  v_perm_b32 v89, v60, v60, v13
  v_perm_b32 v90, v60, v60, v14
  v_perm_b32 v91, v60, v60, v15
  v_perm_b32 v92, v60, v60, v16
  v_perm_b32 v93, v60, v60, v17
  v_perm_b32 v94, v60, v60, v18
  v_perm_b32 v95, v60, v60, v19
  s_waitcnt vmcnt(15)
  v_mfma_f32_16x16x32_bf16 v[80:83], a[64:67], v[88:91], v[80:83]
  s_waitcnt vmcnt(14)
  v_mfma_f32_16x16x32_bf16 v[84:87], a[68:71], v[88:91], v[84:87]
  s_waitcnt vmcnt(13)
  v_mfma_f32_16x16x32_bf16 v[80:83], a[72:75], v[92:95], v[80:83]
  s_waitcnt vmcnt(12)
  v_mfma_f32_16x16x32_bf16 v[84:87], a[76:79], v[92:95], v[84:87]
  v_perm_b32 v96, v61, v61, v12
  v_perm_b32 v97, v61, v61, v13
  v_perm_b32 v98, v61, v61, v14
  v_perm_b32 v99, v61, v61, v15
  v_perm_b32 v100, v61, v61, v16
  v_perm_b32 v101, v61, v61, v17
  v_perm_b32 v102, v61, v61, v18
  v_perm_b32 v103, v61, v61, v19
  s_waitcnt vmcnt(11)
  v_mfma_f32_16x16x32_bf16 v[80:83], a[80:83], v[96:99], v[80:83]
  s_waitcnt vmcnt(10)
  v_mfma_f32_16x16x32_bf16 v[84:87], a[84:87], v[96:99], v[84:87]
  s_waitcnt vmcnt(9)
  v_mfma_f32_16x16x32_bf16 v[80:83], a[88:91], v[100:103], v[80:83]
  s_waitcnt vmcnt(8)
  v_mfma_f32_16x16x32_bf16 v[84:87], a[92:95], v[100:103], v[84:87]
  v_perm_b32 v88, v62, v62, v12
  v_perm_b32 v89, v62, v62, v13
  v_perm_b32 v90, v62, v62, v14
  v_perm_b32 v91, v62, v62, v15
  v_perm_b32 v92, v62, v62, v16
  v_perm_b32 v93, v62, v62, v17
  v_perm_b32 v94, v62, v62, v18
  v_perm_b32 v95, v62, v62, v19
  s_waitcnt vmcnt(7)
  v_mfma_f32_16x16x32_bf16 v[80:83], a[96:99], v[88:91], v[80:83]
  s_waitcnt vmcnt(6)
  v_mfma_f32_16x16x32_bf16 v[84:87], a[100:103], v[88:91], v[84:87]
  s_waitcnt vmcnt(5)
  v_mfma_f32_16x16x32_bf16 v[80:83], a[104:107], v[92:95], v[80:83]
  s_waitcnt vmcnt(4)
  v_mfma_f32_16x16x32_bf16 v[84:87], a[108:111], v[92:95], v[84:87]
  v_perm_b32 v96, v63, v63, v12
  v_perm_b32 v97, v63, v63, v13
  v_perm_b32 v98, v63, v63, v14
  v_perm_b32 v99, v63, v63, v15
  v_perm_b32 v100, v63, v63, v16
  v_perm_b32 v101, v63, v63, v17
  v_perm_b32 v102, v63, v63, v18
  v_perm_b32 v103, v63, v63, v19
  s_waitcnt vmcnt(3)
  v_mfma_f32_16x16x32_bf16 v[80:83], a[112:115], v[96:99], v[80:83]
  s_waitcnt vmcnt(2)
  v_mfma_f32_16x16x32_bf16 v[84:87], a[116:119], v[96:99], v[84:87]
  s_waitcnt vmcnt(1)
  v_mfma_f32_16x16x32_bf16 v[80:83], a[120:123], v[100:103], v[80:83]
  s_waitcnt vmcnt(0)
  v_mfma_f32_16x16x32_bf16 v[84:87], a[124:127], v[100:103], v[84:87]
  s_nop 7
  v_add_f32_dpp v124, v84, v80 row_ror:8 row_mask:0xf bank_mask:0x3
  v_add_f32_dpp v125, v85, v81 row_ror:8 row_mask:0xf bank_mask:0x3
  v_add_f32_dpp v126, v86, v82 row_ror:8 row_mask:0xf bank_mask:0x3
  v_add_f32_dpp v127, v87, v83 row_ror:8 row_mask:0xf bank_mask:0x3
  v_add_f32_dpp v124, v80, v84 row_ror:8 row_mask:0xf bank_mask:0xc
  v_add_f32_dpp v125, v81, v85 row_ror:8 row_mask:0xf bank_mask:0xc
  v_add_f32_dpp v126, v82, v86 row_ror:8 row_mask:0xf bank_mask:0xc
  v_add_f32_dpp v127, v83, v87 row_ror:8 row_mask:0xf bank_mask:0xc
  v_mul_f32 v124, v208, v124
  v_mul_f32 v125, v208, v125
  v_mul_f32 v126, v208, v126
  v_mul_f32 v127, v208, v127
  v_cvt_pk_bf16_f32 v128, v124, v125
  v_cvt_pk_bf16_f32 v129, v126, v127
  v_cmp_lt_u32 vcc, 7, v2
  v_lshlrev_b32 v130, 16, v128
  v_and_b32 v131, 0xffff0000, v128
  v_lshlrev_b32 v132, 16, v129
  v_and_b32 v133, 0xffff0000, v129
  v_sub_f32 v124, v124, v130
  v_sub_f32 v125, v125, v131
  v_sub_f32 v126, v126, v132
  v_sub_f32 v127, v127, v133
  v_cvt_pk_bf16_f32 v130, v124, v125
  v_cvt_pk_bf16_f32 v131, v126, v127
  v_cndmask_b32 v128, v128, v130, vcc
  v_cndmask_b32 v129, v129, v131, vcc
  ds_write_b64 v244, v[128:129] offset:9216
  s_waitcnt lgkmcnt(0)
  s_barrier
  ds_read_b128 v[104:107], v245 offset:9216
  ds_read_b128 v[108:111], v245 offset:9280
  ds_read_b128 v[112:115], v245 offset:9344
  ds_read_b128 v[116:119], v245 offset:9408
  s_waitcnt lgkmcnt(3)
  v_mfma_f32_16x16x32_bf16 v[176:179], v[104:107], a[128:131], 0
  v_mfma_f32_16x16x32_bf16 v[192:195], v[104:107], a[144:147], 0
  v_mfma_f32_16x16x32_bf16 v[180:183], v[104:107], a[132:135], 0
  v_mfma_f32_16x16x32_bf16 v[196:199], v[104:107], a[148:151], 0
  s_waitcnt lgkmcnt(2)
  v_mfma_f32_16x16x32_bf16 v[176:179], v[108:111], a[160:163], v[176:179]
  v_mfma_f32_16x16x32_bf16 v[192:195], v[108:111], a[176:179], v[192:195]
  v_mfma_f32_16x16x32_bf16 v[180:183], v[108:111], a[164:167], v[180:183]
  v_mfma_f32_16x16x32_bf16 v[196:199], v[108:111], a[180:183], v[196:199]
  s_waitcnt lgkmcnt(1)
  v_mfma_f32_16x16x32_bf16 v[176:179], v[112:115], a[192:195], v[176:179]
  v_mfma_f32_16x16x32_bf16 v[192:195], v[112:115], a[208:211], v[192:195]
  v_mfma_f32_16x16x32_bf16 v[180:183], v[112:115], a[196:199], v[180:183]
  v_mfma_f32_16x16x32_bf16 v[196:199], v[112:115], a[212:215], v[196:199]
  s_waitcnt lgkmcnt(0)
  v_mfma_f32_16x16x32_bf16 v[176:179], v[116:119], a[224:227], v[176:179]
  v_mfma_f32_16x16x32_bf16 v[192:195], v[116:119], a[240:243], v[192:195]
  v_mfma_f32_16x16x32_bf16 v[180:183], v[116:119], a[228:231], v[180:183]
  v_mfma_f32_16x16x32_bf16 v[196:199], v[116:119], a[244:247], v[196:199]
  v_mfma_f32_16x16x32_bf16 v[184:187], v[104:107], a[136:139], 0
  v_mfma_f32_16x16x32_bf16 v[200:203], v[104:107], a[152:155], 0
  v_mfma_f32_16x16x32_bf16 v[184:187], v[108:111], a[168:171], v[184:187]
  v_mfma_f32_16x16x32_bf16 v[200:203], v[108:111], a[184:187], v[200:203]
  v_mfma_f32_16x16x32_bf16 v[184:187], v[112:115], a[200:203], v[184:187]
  v_mfma_f32_16x16x32_bf16 v[200:203], v[112:115], a[216:219], v[200:203]
  v_add_f32 v176, v176, v177
  v_add_f32 v192, v192, v193
  v_mfma_f32_16x16x32_bf16 v[184:187], v[116:119], a[232:235], v[184:187]
  v_mfma_f32_16x16x32_bf16 v[200:203], v[116:119], a[248:251], v[200:203]
  v_add_f32 v180, v180, v181
  v_add_f32 v196, v196, v197
  v_mfma_f32_16x16x32_bf16 v[188:191], v[104:107], a[140:143], 0
  v_mfma_f32_16x16x32_bf16 v[204:207], v[104:107], a[156:159], 0
  v_permlane32_swap_b32 v176, v192
  v_permlane32_swap_b32 v180, v196
  v_mfma_f32_16x16x32_bf16 v[188:191], v[108:111], a[172:175], v[188:191]
  v_mfma_f32_16x16x32_bf16 v[204:207], v[108:111], a[188:191], v[204:207]
  v_add_f32 v176, v176, v192
  v_add_f32 v180, v180, v196
  v_mfma_f32_16x16x32_bf16 v[188:191], v[112:115], a[204:207], v[188:191]
  v_mfma_f32_16x16x32_bf16 v[204:207], v[112:115], a[220:223], v[204:207]
  v_mfma_f32_16x16x32_bf16 v[188:191], v[116:119], a[236:239], v[188:191]
  v_mfma_f32_16x16x32_bf16 v[204:207], v[116:119], a[252:255], v[204:207]
  v_add_f32 v184, v184, v185
  v_add_f32 v200, v200, v201
  s_nop 1
  v_permlane32_swap_b32 v184, v200
  v_add_f32 v184, v184, v200
  s_nop 1
  v_permlane16_swap_b32 v176, v184
  v_add_f32 v188, v188, v189
  v_add_f32 v204, v204, v205
  v_add_f32 v124, v176, v184
  s_nop 0
  v_permlane32_swap_b32 v188, v204
  v_add_f32 v188, v188, v204
  s_nop 1
  v_permlane16_swap_b32 v180, v188
  v_add_f32 v125, v180, v188
  buffer_store_dwordx2 v[124:125], v8, s[48:51], 0 offen sc1
  s_cmp_eq_u32 s86, 1
  s_cbranch_scc1 L_m1
  s_cmp_eq_u32 s86, 2
  s_cbranch_scc0 L_fin
  s_cmp_lt_u32 s3, 2
  s_cbranch_scc0 L_fin
  v_lshlrev_b32 v214, 16, v214
  v_lshlrev_b32 v215, 16, v215
  s_mov_b32 s87, 32768
  s_mov_b32 s81, 0
  buffer_load_dwordx4 v[176:179], v235, s[48:51], s81 offen offset:0 sc1
  buffer_load_dwordx4 v[180:183], v235, s[48:51], s81 offen offset:1024 sc1
  buffer_load_dwordx4 v[184:187], v235, s[48:51], s81 offen offset:2048 sc1
  buffer_load_dwordx4 v[188:191], v235, s[48:51], s81 offen offset:3072 sc1
  s_mov_b32 s81, 4096
  buffer_load_dwordx4 v[192:195], v235, s[48:51], s81 offen offset:0 sc1
  buffer_load_dwordx4 v[196:199], v235, s[48:51], s81 offen offset:1024 sc1
  buffer_load_dwordx4 v[200:203], v235, s[48:51], s81 offen offset:2048 sc1
  buffer_load_dwordx4 v[204:207], v235, s[48:51], s81 offen offset:3072 sc1
  s_mov_b32 s81, 0
  buffer_load_dwordx4 v[32:35], v235, s[48:51], s81 offen offset:0 sc1
  buffer_load_dwordx4 v[36:39], v235, s[48:51], s81 offen offset:1024 sc1
  buffer_load_dwordx4 v[40:43], v235, s[48:51], s81 offen offset:2048 sc1
  buffer_load_dwordx4 v[44:47], v235, s[48:51], s81 offen offset:3072 sc1
  s_mov_b32 s81, 4096
  buffer_load_dwordx4 v[48:51], v235, s[48:51], s81 offen offset:0 sc1
  buffer_load_dwordx4 v[52:55], v235, s[48:51], s81 offen offset:1024 sc1
  buffer_load_dwordx4 v[56:59], v235, s[48:51], s81 offen offset:2048 sc1
  buffer_load_dwordx4 v[60:63], v235, s[48:51], s81 offen offset:3072 sc1
  s_mov_b32 s81, 0
  buffer_load_dwordx4 v[144:147], v235, s[48:51], s81 offen offset:0 sc1
  buffer_load_dwordx4 v[148:151], v235, s[48:51], s81 offen offset:1024 sc1
  buffer_load_dwordx4 v[152:155], v235, s[48:51], s81 offen offset:2048 sc1
  buffer_load_dwordx4 v[156:159], v235, s[48:51], s81 offen offset:3072 sc1
  s_mov_b32 s81, 4096
  buffer_load_dwordx4 v[160:163], v235, s[48:51], s81 offen offset:0 sc1
  buffer_load_dwordx4 v[164:167], v235, s[48:51], s81 offen offset:1024 sc1
  buffer_load_dwordx4 v[168:171], v235, s[48:51], s81 offen offset:2048 sc1
  buffer_load_dwordx4 v[172:175], v235, s[48:51], s81 offen offset:3072 sc1
L_g1:
  s_waitcnt vmcnt(22)
  v_pk_add_f32 v[124:125], v[176:177], v[180:181]
  v_pk_add_f32 v[126:127], v[178:179], v[182:183]
  s_waitcnt vmcnt(21)
  v_pk_add_f32 v[124:125], v[124:125], v[184:185]
  v_pk_add_f32 v[126:127], v[126:127], v[186:187]
  s_waitcnt vmcnt(20)
  v_pk_add_f32 v[124:125], v[124:125], v[188:189]
  v_pk_add_f32 v[126:127], v[126:127], v[190:191]
  s_waitcnt vmcnt(19)
  v_pk_add_f32 v[124:125], v[124:125], v[192:193]
  v_pk_add_f32 v[126:127], v[126:127], v[194:195]
  s_waitcnt vmcnt(18)
  v_pk_add_f32 v[124:125], v[124:125], v[196:197]
  v_pk_add_f32 v[126:127], v[126:127], v[198:199]
  s_waitcnt vmcnt(17)
  v_pk_add_f32 v[124:125], v[124:125], v[200:201]
  v_pk_add_f32 v[126:127], v[126:127], v[202:203]
  s_waitcnt vmcnt(16)
  v_pk_add_f32 v[124:125], v[124:125], v[204:205]
  v_pk_add_f32 v[126:127], v[126:127], v[206:207]
  v_cmp_u_f32 vcc, v124, v125
  v_cmp_u_f32 s[90:91], v126, v127
  s_or_b64 vcc, vcc, s[90:91]
  s_cbranch_vccz L_g1_ok
  s_mov_b32 s81, 0
  buffer_load_dwordx4 v[176:179], v235, s[48:51], s81 offen offset:0 sc1
  buffer_load_dwordx4 v[180:183], v235, s[48:51], s81 offen offset:1024 sc1
  buffer_load_dwordx4 v[184:187], v235, s[48:51], s81 offen offset:2048 sc1
  buffer_load_dwordx4 v[188:191], v235, s[48:51], s81 offen offset:3072 sc1
  s_mov_b32 s81, 4096
  buffer_load_dwordx4 v[192:195], v235, s[48:51], s81 offen offset:0 sc1
  buffer_load_dwordx4 v[196:199], v235, s[48:51], s81 offen offset:1024 sc1
  buffer_load_dwordx4 v[200:203], v235, s[48:51], s81 offen offset:2048 sc1
  buffer_load_dwordx4 v[204:207], v235, s[48:51], s81 offen offset:3072 sc1
  s_waitcnt vmcnt(22)
  v_pk_add_f32 v[124:125], v[32:33], v[36:37]
  v_pk_add_f32 v[126:127], v[34:35], v[38:39]
  s_waitcnt vmcnt(21)
  v_pk_add_f32 v[124:125], v[124:125], v[40:41]
  v_pk_add_f32 v[126:127], v[126:127], v[42:43]
  s_waitcnt vmcnt(20)
  v_pk_add_f32 v[124:125], v[124:125], v[44:45]
  v_pk_add_f32 v[126:127], v[126:127], v[46:47]
  s_waitcnt vmcnt(19)
  v_pk_add_f32 v[124:125], v[124:125], v[48:49]
  v_pk_add_f32 v[126:127], v[126:127], v[50:51]
  s_waitcnt vmcnt(18)
  v_pk_add_f32 v[124:125], v[124:125], v[52:53]
  v_pk_add_f32 v[126:127], v[126:127], v[54:55]
  s_waitcnt vmcnt(17)
  v_pk_add_f32 v[124:125], v[124:125], v[56:57]
  v_pk_add_f32 v[126:127], v[126:127], v[58:59]
  s_waitcnt vmcnt(16)
  v_pk_add_f32 v[124:125], v[124:125], v[60:61]
  v_pk_add_f32 v[126:127], v[126:127], v[62:63]
  v_cmp_u_f32 vcc, v124, v125
  v_cmp_u_f32 s[90:91], v126, v127
  s_or_b64 vcc, vcc, s[90:91]
  s_cbranch_vccz L_g1_ok
  s_mov_b32 s81, 0
  buffer_load_dwordx4 v[32:35], v235, s[48:51], s81 offen offset:0 sc1
  buffer_load_dwordx4 v[36:39], v235, s[48:51], s81 offen offset:1024 sc1
  buffer_load_dwordx4 v[40:43], v235, s[48:51], s81 offen offset:2048 sc1
  buffer_load_dwordx4 v[44:47], v235, s[48:51], s81 offen offset:3072 sc1
  s_mov_b32 s81, 4096
  buffer_load_dwordx4 v[48:51], v235, s[48:51], s81 offen offset:0 sc1
  buffer_load_dwordx4 v[52:55], v235, s[48:51], s81 offen offset:1024 sc1
  buffer_load_dwordx4 v[56:59], v235, s[48:51], s81 offen offset:2048 sc1
  buffer_load_dwordx4 v[60:63], v235, s[48:51], s81 offen offset:3072 sc1
  s_waitcnt vmcnt(22)
  v_pk_add_f32 v[124:125], v[144:145], v[148:149]
  v_pk_add_f32 v[126:127], v[146:147], v[150:151]
  s_waitcnt vmcnt(21)
  v_pk_add_f32 v[124:125], v[124:125], v[152:153]
  v_pk_add_f32 v[126:127], v[126:127], v[154:155]
  s_waitcnt vmcnt(20)
  v_pk_add_f32 v[124:125], v[124:125], v[156:157]
  v_pk_add_f32 v[126:127], v[126:127], v[158:159]
  s_waitcnt vmcnt(19)
  v_pk_add_f32 v[124:125], v[124:125], v[160:161]
  v_pk_add_f32 v[126:127], v[126:127], v[162:163]
  s_waitcnt vmcnt(18)
  v_pk_add_f32 v[124:125], v[124:125], v[164:165]
  v_pk_add_f32 v[126:127], v[126:127], v[166:167]
  s_waitcnt vmcnt(17)
  v_pk_add_f32 v[124:125], v[124:125], v[168:169]
  v_pk_add_f32 v[126:127], v[126:127], v[170:171]
  s_waitcnt vmcnt(16)
  v_pk_add_f32 v[124:125], v[124:125], v[172:173]
  v_pk_add_f32 v[126:127], v[126:127], v[174:175]
  v_cmp_u_f32 vcc, v124, v125
  v_cmp_u_f32 s[90:91], v126, v127
  s_or_b64 vcc, vcc, s[90:91]
  s_cbranch_vccz L_g1_ok
  s_mov_b32 s81, 0
  buffer_load_dwordx4 v[144:147], v235, s[48:51], s81 offen offset:0 sc1
  buffer_load_dwordx4 v[148:151], v235, s[48:51], s81 offen offset:1024 sc1
  buffer_load_dwordx4 v[152:155], v235, s[48:51], s81 offen offset:2048 sc1
  buffer_load_dwordx4 v[156:159], v235, s[48:51], s81 offen offset:3072 sc1
  s_mov_b32 s81, 4096
  buffer_load_dwordx4 v[160:163], v235, s[48:51], s81 offen offset:0 sc1
  buffer_load_dwordx4 v[164:167], v235, s[48:51], s81 offen offset:1024 sc1
  buffer_load_dwordx4 v[168:171], v235, s[48:51], s81 offen offset:2048 sc1
  buffer_load_dwordx4 v[172:175], v235, s[48:51], s81 offen offset:3072 sc1
  s_sub_u32 s87, s87, 1
  s_cbranch_scc0 L_g1
L_g1_ok:
  v_permlane32_swap_b32 v124, v126
  v_permlane32_swap_b32 v125, v127
  v_add_f32 v124, v124, v126
  v_add_f32 v125, v125, v127
  s_nop 1
  v_permlane16_swap_b32 v124, v125
  v_add_f32 v124, v124, v125
  s_nop 1
  v_add_f32_dpp v124, v124, v124 row_ror:4 row_mask:0xf bank_mask:0xf
  s_nop 1
  v_add_f32_dpp v124, v124, v124 row_ror:8 row_mask:0xf bank_mask:0xf
  v_cvt_pk_bf16_f32 v124, 0, v124
  v_add_f32 v124, v214, v124
  v_cvt_pk_bf16_f32 v216, 0, v124
  buffer_store_dword v216, v11, s[48:51], 0 offen sc1
  v_and_b32 v128, 3, v2
  v_lshl_add_u32 v128, v128, 4, v3
  v_lshlrev_b32 v128, 2, v128
  ds_bpermute_b32 v216, v128, v216
  s_waitcnt lgkmcnt(0)
  s_mov_b32 s87, 32768
  s_mov_b32 s81, 4096
L_gt2:
  buffer_load_dwordx4 v[176:179], v241, s[48:51], s81 offen offset:2048 sc1
  s_waitcnt vmcnt(0)
  v_cmp_u_f32 vcc, v176, v176
  s_cmp_eq_u64 vcc, -1
  s_cbranch_scc0 L_gt2_ok
  s_sub_u32 s87, s87, 1
  s_cbranch_scc0 L_gt2
L_gt2_ok:
  s_mov_b32 s87, 32768
  s_mov_b32 s81, 0
  buffer_load_dwordx4 v[176:179], v241, s[48:51], s81 offen offset:0 sc1
  buffer_load_dwordx4 v[180:183], v241, s[48:51], s81 offen offset:1024 sc1
  buffer_load_dwordx4 v[184:187], v241, s[48:51], s81 offen offset:2048 sc1
  buffer_load_dwordx4 v[188:191], v241, s[48:51], s81 offen offset:3072 sc1
  s_mov_b32 s81, 4096
  buffer_load_dwordx4 v[192:195], v241, s[48:51], s81 offen offset:0 sc1
  buffer_load_dwordx4 v[196:199], v241, s[48:51], s81 offen offset:1024 sc1
  buffer_load_dwordx4 v[200:203], v241, s[48:51], s81 offen offset:2048 sc1
  s_mov_b32 s81, 0
  buffer_load_dwordx4 v[32:35], v241, s[48:51], s81 offen offset:0 sc1
  buffer_load_dwordx4 v[36:39], v241, s[48:51], s81 offen offset:1024 sc1
  buffer_load_dwordx4 v[40:43], v241, s[48:51], s81 offen offset:2048 sc1
  buffer_load_dwordx4 v[44:47], v241, s[48:51], s81 offen offset:3072 sc1
  s_mov_b32 s81, 4096
  buffer_load_dwordx4 v[48:51], v241, s[48:51], s81 offen offset:0 sc1
  buffer_load_dwordx4 v[52:55], v241, s[48:51], s81 offen offset:1024 sc1
  buffer_load_dwordx4 v[56:59], v241, s[48:51], s81 offen offset:2048 sc1
L_g2:
  s_waitcnt vmcnt(12)
  v_pk_add_f32 v[124:125], v[176:177], v[180:181]
  v_pk_add_f32 v[126:127], v[178:179], v[182:183]
  s_waitcnt vmcnt(11)
  v_pk_add_f32 v[124:125], v[124:125], v[184:185]
  v_pk_add_f32 v[126:127], v[126:127], v[186:187]
  s_waitcnt vmcnt(10)
  v_pk_add_f32 v[124:125], v[124:125], v[188:189]
  v_pk_add_f32 v[126:127], v[126:127], v[190:191]
  s_waitcnt vmcnt(9)
  v_pk_add_f32 v[124:125], v[124:125], v[192:193]
  v_pk_add_f32 v[126:127], v[126:127], v[194:195]
  s_waitcnt vmcnt(8)
  v_pk_add_f32 v[124:125], v[124:125], v[196:197]
  v_pk_add_f32 v[126:127], v[126:127], v[198:199]
  s_waitcnt vmcnt(7)
  v_pk_add_f32 v[124:125], v[124:125], v[200:201]
  v_pk_add_f32 v[126:127], v[126:127], v[202:203]
  v_cmp_u_f32 vcc, v124, v125
  v_cmp_u_f32 s[90:91], v126, v127
  s_or_b64 vcc, vcc, s[90:91]
  s_cbranch_vccz L_g2_ok
  s_mov_b32 s81, 0
  buffer_load_dwordx4 v[176:179], v241, s[48:51], s81 offen offset:0 sc1
  buffer_load_dwordx4 v[180:183], v241, s[48:51], s81 offen offset:1024 sc1
  buffer_load_dwordx4 v[184:187], v241, s[48:51], s81 offen offset:2048 sc1
  buffer_load_dwordx4 v[188:191], v241, s[48:51], s81 offen offset:3072 sc1
  s_mov_b32 s81, 4096
  buffer_load_dwordx4 v[192:195], v241, s[48:51], s81 offen offset:0 sc1
  buffer_load_dwordx4 v[196:199], v241, s[48:51], s81 offen offset:1024 sc1
  buffer_load_dwordx4 v[200:203], v241, s[48:51], s81 offen offset:2048 sc1
  s_waitcnt vmcnt(12)
  v_pk_add_f32 v[124:125], v[32:33], v[36:37]
  v_pk_add_f32 v[126:127], v[34:35], v[38:39]
  s_waitcnt vmcnt(11)
  v_pk_add_f32 v[124:125], v[124:125], v[40:41]
  v_pk_add_f32 v[126:127], v[126:127], v[42:43]
  s_waitcnt vmcnt(10)
  v_pk_add_f32 v[124:125], v[124:125], v[44:45]
  v_pk_add_f32 v[126:127], v[126:127], v[46:47]
  s_waitcnt vmcnt(9)
  v_pk_add_f32 v[124:125], v[124:125], v[48:49]
  v_pk_add_f32 v[126:127], v[126:127], v[50:51]
  s_waitcnt vmcnt(8)
  v_pk_add_f32 v[124:125], v[124:125], v[52:53]
  v_pk_add_f32 v[126:127], v[126:127], v[54:55]
  s_waitcnt vmcnt(7)
  v_pk_add_f32 v[124:125], v[124:125], v[56:57]
  v_pk_add_f32 v[126:127], v[126:127], v[58:59]
  v_cmp_u_f32 vcc, v124, v125
  v_cmp_u_f32 s[90:91], v126, v127
  s_or_b64 vcc, vcc, s[90:91]
  s_cbranch_vccz L_g2_ok
  s_mov_b32 s81, 0
  buffer_load_dwordx4 v[32:35], v241, s[48:51], s81 offen offset:0 sc1
  buffer_load_dwordx4 v[36:39], v241, s[48:51], s81 offen offset:1024 sc1
  buffer_load_dwordx4 v[40:43], v241, s[48:51], s81 offen offset:2048 sc1
  buffer_load_dwordx4 v[44:47], v241, s[48:51], s81 offen offset:3072 sc1
  s_mov_b32 s81, 4096
  buffer_load_dwordx4 v[48:51], v241, s[48:51], s81 offen offset:0 sc1
  buffer_load_dwordx4 v[52:55], v241, s[48:51], s81 offen offset:1024 sc1
  buffer_load_dwordx4 v[56:59], v241, s[48:51], s81 offen offset:2048 sc1
  s_sub_u32 s87, s87, 1
  s_cbranch_scc0 L_g2
L_g2_ok:
  v_permlane32_swap_b32 v124, v126
  v_permlane32_swap_b32 v125, v127
  v_add_f32 v124, v124, v126
  v_add_f32 v125, v125, v127
  s_nop 1
  v_permlane16_swap_b32 v124, v125
  v_add_f32 v124, v124, v125
  s_nop 1
  v_add_f32_dpp v124, v124, v124 row_ror:4 row_mask:0xf bank_mask:0xf
  s_nop 1
  v_add_f32_dpp v124, v124, v124 row_ror:8 row_mask:0xf bank_mask:0xf
  v_cvt_pk_bf16_f32 v124, 0, v124
  v_add_f32 v124, v215, v124
  v_cvt_pk_bf16_f32 v124, 0, v124
  v_add_f32 v124, v216, v124
  v_cvt_pk_bf16_f32 v124, v124, v124
  buffer_store_short v124, v218, s[76:79], 0 offen
  s_branch L_fin
L_m1:
  s_lshl_b32 s81, s3, 9
  v_lshrrev_b32 v124, 5, v1
  v_lshlrev_b32 v124, 8, v124
  v_and_b32 v125, 31, v1
  v_lshl_add_u32 v124, v125, 3, v124
  v_add_u32 v224, s81, v124
  v_and_b32 v124, 1, v2
  v_lshlrev_b32 v124, 8, v124
  v_lshl_add_u32 v124, v3, 4, v124
  v_add_u32 v225, s81, v124
  s_lshl_b32 s81, s3, 7
  v_lshlrev_b32 v124, 2, v2
  v_add_u32 v226, s81, v124
  v_lshrrev_b32 v124, 3, v2
  v_lshlrev_b32 v124, 6, v124
  v_and_b32 v125, 3, v2
  v_lshl_add_u32 v125, v3, 2, v125
  v_lshl_add_u32 v227, v125, 2, v124
  v_lshlrev_b32 v213, 16, v213
  v_mov_b32 v125, 0x3f803f80
  v_lshlrev_b32 v124, 2, v1
  ds_write_b32 v124, v125 offset:14592
  v_and_b32 v124, 3, v2
  v_cmp_eq_u32 vcc, 2, v124
  v_mov_b32 v125, 3328
  s_nop 0
  v_cndmask_b32 v225, v225, v125, vcc
  s_lshl_b32 s81, s3, 8
  v_and_b32 v124, 1, v3
  v_cmp_eq_u32 s[90:91], 1, v124
  v_lshlrev_b32 v124, 7, v124
  v_lshl_add_u32 v124, v2, 3, v124
  v_add_u32 v226, s81, v124
  v_lshrrev_b32 v124, 3, v2
  v_lshlrev_b32 v240, 8, v124
  v_lshlrev_b32 v124, 7, v124
  v_and_b32 v125, 3, v2
  v_lshl_add_u32 v125, v3, 2, v125
  v_lshl_add_u32 v227, v125, 3, v124
  v_mov_b32 v239, v235
  v_mov_b32 v241, v11
  v_mov_b32 v235, 2146435072
  v_mov_b32 v11, 2146435072
  s_mov_b32 s89, 0
  s_lshl_b32 s94, s3, 9
  v_lshlrev_b32 v233, 3, v1
  v_add_u32 v232, s94, v233
L_m1p:
  s_mov_b32 s87, 32768
L_g3:
  buffer_load_dwordx4 v[176:179], v235, s[48:51], s94 offen sc1
  s_waitcnt vmcnt(0)
  v_add_f32 v124, v176, v177
  v_add_f32 v125, v178, v179
  v_add_f32 v124, v124, v125
  v_cmp_u_f32 vcc, v124, v124
  s_cbranch_vccz L_g3_ok
  s_sub_u32 s87, s87, 1
  s_cbranch_scc0 L_g3
L_g3_ok:
  v_cvt_pk_bf16_f32 v138, v176, v177
  v_cvt_pk_bf16_f32 v139, v178, v179
  ds_write_b64 v224, v[138:139] offset:11264
  ds_read_b128 v[104:107], v225 offset:11264
  ds_read_b128 v[108:111], v225 offset:11328
  ds_read_b128 v[112:115], v225 offset:11392
  ds_read_b128 v[116:119], v225 offset:11456
  v_add_f32_dpp v124, v124, v124 row_ror:1 row_mask:0xf bank_mask:0xf
  s_nop 1
  v_add_f32_dpp v124, v124, v124 row_ror:2 row_mask:0xf bank_mask:0xf
  s_nop 1
  v_add_f32_dpp v124, v124, v124 row_ror:4 row_mask:0xf bank_mask:0xf
  s_nop 1
  v_add_f32_dpp v124, v124, v124 row_ror:8 row_mask:0xf bank_mask:0xf
  v_mov_b32 v125, v124
  s_nop 1
  v_permlane16_swap_b32 v124, v125
  v_add_f32 v124, v124, v125
  v_mul_f32 v126, 0x3c000000, v124
  v_sub_f32 v128, v176, v126
  v_sub_f32 v129, v177, v126
  v_sub_f32 v130, v178, v126
  v_sub_f32 v131, v179, v126
  v_mul_f32 v127, v128, v128
  v_mul_f32 v125, v129, v129
  v_fmac_f32 v127, v130, v130
  v_fmac_f32 v125, v131, v131
  v_add_f32 v127, v127, v125
  s_waitcnt lgkmcnt(3)
  v_mfma_f32_16x16x32_bf16 v[120:123], v[104:107], v[144:147], 0
  v_add_f32_dpp v127, v127, v127 row_ror:1 row_mask:0xf bank_mask:0xf
  s_waitcnt lgkmcnt(2)
  v_mfma_f32_16x16x32_bf16 v[120:123], v[108:111], v[148:151], v[120:123]
  v_add_f32_dpp v127, v127, v127 row_ror:2 row_mask:0xf bank_mask:0xf
  s_waitcnt lgkmcnt(1)
  v_mfma_f32_16x16x32_bf16 v[120:123], v[112:115], v[152:155], v[120:123]
  v_add_f32_dpp v127, v127, v127 row_ror:4 row_mask:0xf bank_mask:0xf
  s_waitcnt lgkmcnt(0)
  v_mfma_f32_16x16x32_bf16 v[120:123], v[116:119], v[156:159], v[120:123]
  v_add_f32_dpp v127, v127, v127 row_ror:8 row_mask:0xf bank_mask:0xf
  v_mov_b32 v125, v127
  s_nop 1
  v_permlane16_swap_b32 v127, v125
  v_add_f32 v127, v127, v125
  ds_write_b64 v232, v[126:127] offset:4096
  s_nop 0
  v_cndmask_b32 v128, v120, v121, s[90:91]
  v_mov_b32 v129, v122
  ds_write_b64 v226, v[128:129] offset:0
  s_waitcnt lgkmcnt(0)
  s_barrier
  ds_read_b64 v[128:129], v240 offset:4096
  ds_read_b64 v[130:131], v240 offset:4608
  ds_read_b64 v[132:133], v240 offset:5120
  ds_read_b64 v[134:135], v240 offset:5632
  ds_read_b64 v[104:105], v227 offset:0
  ds_read_b64 v[106:107], v227 offset:256
  ds_read_b64 v[108:109], v227 offset:512
  ds_read_b64 v[110:111], v227 offset:768
  s_waitcnt lgkmcnt(6)
  v_pk_add_f32 v[136:137], v[128:129], v[130:131]
  s_waitcnt lgkmcnt(4)
  v_pk_add_f32 v[138:139], v[132:133], v[134:135]
  v_pk_add_f32 v[136:137], v[136:137], v[138:139]
  v_mul_f32 v124, 0x3e800000, v136
  v_sub_f32 v128, v128, v124
  v_sub_f32 v130, v130, v124
  v_sub_f32 v132, v132, v124
  v_sub_f32 v134, v134, v124
  v_mul_f32 v125, v128, v128
  v_mul_f32 v126, v130, v130
  v_fmac_f32 v125, v132, v132
  v_fmac_f32 v126, v134, v134
  v_add_f32 v125, v125, v126
  v_mov_b32 v127, v137
  v_fmac_f32 v127, 0x43000000, v125
  s_waitcnt lgkmcnt(0)
  v_pk_add_f32 v[104:105], v[104:105], v[106:107]
  v_pk_add_f32 v[108:109], v[108:109], v[110:111]
  v_pk_add_f32 v[104:105], v[104:105], v[108:109]
  v_mul_f32 v127, 0x3b000000, v127
  v_cvt_pk_bf16_f32 v127, 0, v127
  v_add_f32 v127, 0x3727c5ac, v127
  v_cvt_pk_bf16_f32 v127, 0, v127
  v_sqrt_f32 v127, v127
  s_nop 0
  v_cvt_pk_bf16_f32 v127, 0, v127
  v_rcp_f32 v133, v127
  v_cvt_pk_bf16_f32 v132, 0, v124
  v_fma_f32 v124, -v132, v105, v104
  v_mul_f32 v124, v124, v133
  v_cvt_pk_bf16_f32 v124, 0, v124
  v_add_f32 v124, v213, v124
  v_cvt_pk_bf16_f32 v124, 0, v124
  v_mul_f32 v125, v124, v124
  v_mov_b32 v126, 0xc0135761
  v_fmac_f32 v126, 0xbdd2d3e8, v125
  v_mul_f32 v125, v124, v126
  v_exp_f32 v125, v125
  s_nop 0
  v_add_f32 v125, 1.0, v125
  v_rcp_f32 v125, v125
  s_nop 0
  v_mul_f32 v124, v124, v125
  v_cvt_pk_bf16_f32 v236, v124, v124
  s_nop 1
  v_and_b32_dpp v88, v236, v20 quad_perm:[0,0,0,0] row_mask:0xf bank_mask:0xf
  v_and_b32_dpp v89, v236, v21 quad_perm:[0,0,0,0] row_mask:0xf bank_mask:0xf
  v_and_b32_dpp v90, v236, v22 quad_perm:[0,0,0,0] row_mask:0xf bank_mask:0xf
  v_and_b32_dpp v91, v236, v23 quad_perm:[0,0,0,0] row_mask:0xf bank_mask:0xf
  v_and_b32_dpp v92, v236, v20 quad_perm:[1,1,1,1] row_mask:0xf bank_mask:0xf
  v_and_b32_dpp v93, v236, v21 quad_perm:[1,1,1,1] row_mask:0xf bank_mask:0xf
  v_and_b32_dpp v94, v236, v22 quad_perm:[1,1,1,1] row_mask:0xf bank_mask:0xf
  v_and_b32_dpp v95, v236, v23 quad_perm:[1,1,1,1] row_mask:0xf bank_mask:0xf
  v_mfma_f32_16x16x32_bf16 v[120:123], v[160:163], v[88:91], 0
  v_and_b32_dpp v96, v236, v20 quad_perm:[2,2,2,2] row_mask:0xf bank_mask:0xf
  v_and_b32_dpp v97, v236, v21 quad_perm:[2,2,2,2] row_mask:0xf bank_mask:0xf
  v_and_b32_dpp v98, v236, v22 quad_perm:[2,2,2,2] row_mask:0xf bank_mask:0xf
  v_and_b32_dpp v99, v236, v23 quad_perm:[2,2,2,2] row_mask:0xf bank_mask:0xf
  v_mfma_f32_16x16x32_bf16 v[120:123], v[164:167], v[92:95], v[120:123]
  v_and_b32_dpp v100, v236, v20 quad_perm:[3,3,3,3] row_mask:0xf bank_mask:0xf
  v_and_b32_dpp v101, v236, v21 quad_perm:[3,3,3,3] row_mask:0xf bank_mask:0xf
  v_and_b32_dpp v102, v236, v22 quad_perm:[3,3,3,3] row_mask:0xf bank_mask:0xf
  v_and_b32_dpp v103, v236, v23 quad_perm:[3,3,3,3] row_mask:0xf bank_mask:0xf
  v_mfma_f32_16x16x32_bf16 v[120:123], v[168:171], v[96:99], v[120:123]
  s_nop 0
  v_mfma_f32_16x16x32_bf16 v[120:123], v[172:175], v[100:103], v[120:123]
  s_nop 7
  buffer_store_dwordx4 v[120:123], v11, s[48:51], 0 offen sc1
  s_cmp_eq_u32 s89, 0
  s_cbranch_scc0 L_fin
  s_mov_b32 s89, 1
  v_mov_b32 v235, v239
  v_mov_b32 v11, v241
  s_branch L_m1p
L_fin:
L_end:
  s_endpgm
.section .rodata,"a"
.p2align 6
.amdhsa_kernel sequential_preLN__mha_block_cached__mixer_channel_mlp__decode_kernel
  .amdhsa_next_free_vgpr 512
  .amdhsa_next_free_sgpr 102
  .amdhsa_accum_offset 256
  .amdhsa_group_segment_fixed_size 0
  .amdhsa_kernarg_size 104
  .amdhsa_user_sgpr_count 2
  .amdhsa_user_sgpr_kernarg_segment_ptr 1
  .amdhsa_system_sgpr_workgroup_id_x 1
.end_amdhsa_kernel
```
